```python
import torch

def _softmax(x, axis=-1):
    return torch.softmax(x, dim=axis)
def _gelu(x):
    return torch.nn.functional.gelu(x, approximate="tanh")
def _silu(x):
    return torch.nn.functional.silu(x)
def _sigmoid(x):
    return torch.sigmoid(x)
def _layernorm(x, axis=-1, eps=1e-5):
    m = x.mean(dim=axis, keepdim=True)
    v = x.var(dim=axis, keepdim=True, unbiased=False)
    return (x - m) / torch.sqrt(v + eps)
def _scatter_add(tgt, idx, src, axis=0):
    return tgt.clone().index_add_(axis, idx, src)
def _segment_sum(src, seg, n):
    out = torch.zeros((n,) + src.shape[1:], dtype=src.dtype)
    return out.index_add_(0, seg, src)
def _pad(x, pw):
    flat = tuple(v for pair in reversed(pw) for v in pair)
    return torch.nn.functional.pad(x, flat)

kernel_name = 'recurrent_scan__spectral_fnet__dense_activation_silu__prompt'

def setup_inputs():

    _w = (lambda a: (lambda t: t.to(torch.bfloat16) if t.is_floating_point() else t)(torch.as_tensor(a)))
    def _A_setup():
        B, S, D = 1, 2048, 640
        ns = torch.arange(S)[:, None] * torch.arange(S)[None, :]
        nd = torch.arange(D)[:, None] * torch.arange(D)[None, :]
        Ws_re = torch.cos(-2.0 * torch.pi * ns / S).to(float)
        Ws_im = torch.sin(-2.0 * torch.pi * ns / S).to(float)
        Wd_re = torch.cos(-2.0 * torch.pi * nd / D).to(float)
        Wd_im = torch.sin(-2.0 * torch.pi * nd / D).to(float)
        return {
            "x": _w((lambda *s: torch.randn(*s, dtype=torch.bfloat16) * 0.05)(B, S, D)),
            "dft_seq_re": _w(Ws_re),
            "dft_seq_im": _w(Ws_im),
            "dft_hid_re": _w(Wd_re),
            "dft_hid_im": _w(Wd_im),
        }
    _A_in = _A_setup()

    def _B_setup():
        B, S, D, F = 1, 2048, 640, 1536
        return {
            "x": _w((lambda *s: torch.randn(*s, dtype=torch.bfloat16) * 0.05)(B, S, D)),
            "w1": _w((lambda *s: torch.randn(*s, dtype=torch.bfloat16) * 0.2)(D, F) * (D ** -0.5)),
            "w2": _w((lambda *s: torch.randn(*s, dtype=torch.bfloat16) * 0.05)(F, D) * (F ** -0.5)),
        }
    _B_in = _B_setup()

    return {
        "A_x": _A_in["x"],
        "A_dft_seq_re": _A_in["dft_seq_re"],
        "A_dft_seq_im": _A_in["dft_seq_im"],
        "A_dft_hid_re": _A_in["dft_hid_re"],
        "A_dft_hid_im": _A_in["dft_hid_im"],
        "B_x": _B_in["x"],
        "B_w1": _B_in["w1"],
        "B_w2": _B_in["w2"],
    }

def reference(A_x, A_dft_seq_re, A_dft_seq_im, A_dft_hid_re, A_dft_hid_im, B_x, B_w1, B_w2):
    def _A_ref(x, dft_seq_re, dft_seq_im, dft_hid_re, dft_hid_im):
        a = torch.einsum("bsd,ed->bse", x, dft_hid_re)
        b = torch.einsum("bsd,ed->bse", x, dft_hid_im)
        y = torch.einsum("ts,bse->bte", dft_seq_re, a) - torch.einsum("ts,bse->bte", dft_seq_im, b)
        return y

    def _B_ref(x, w1, w2):
        h = torch.einsum("bsd,df->bsf", x, w1)
        h = _silu(h)
        out = torch.einsum("bsf,fd->bsd", h, w2)
        return out

    x = A_x
    xn = _layernorm(x, axis=-1)
    s = _A_ref(xn, A_dft_seq_re, A_dft_seq_im, A_dft_hid_re, A_dft_hid_im)
    g = _silu(_B_ref(xn, B_w1, B_w2))
    return x + s * g
```

```asm
; @launch kernel=recurrent_scan__spectral_fnet__dense_activation_silu__prompt_kernel grid=(256,1,1) block=(768,1,1) lds=148864
; @launch kernel=fnet_l2_kernel grid=(256,1,1) block=(256,1,1) lds=143360
.amdgcn_target "amdgcn-amd-amdhsa--gfx950"
.text
.globl recurrent_scan__spectral_fnet__dense_activation_silu__prompt_kernel
.p2align 8
.type recurrent_scan__spectral_fnet__dense_activation_silu__prompt_kernel,@function
recurrent_scan__spectral_fnet__dense_activation_silu__prompt_kernel:
  s_cmp_ge_u32 s2, 256
  s_cbranch_scc1 L1_END
  s_load_dwordx2 s[28:29], s[0:1], 0
  s_load_dwordx2 s[30:31], s[0:1], 24
  s_load_dwordx2 s[32:33], s[0:1], 32
  s_load_dwordx2 s[34:35], s[0:1], 48
  s_load_dwordx2 s[36:37], s[0:1], 56
  s_load_dwordx2 s[38:39], s[0:1], 80
  v_lshrrev_b32 v2, 6, v0
  v_and_b32 v1, 63, v0
  v_readfirstlane_b32 s3, v2
  s_and_b32 s40, s2, 7
  s_lshr_b32 s41, s2, 3
  s_lshr_b32 s5, s40, 1
  s_sub_u32 s42, 7, s5
  s_bitcmp1_b32 s41, 0
  s_cselect_b32 s5, s42, s5
  s_and_b32 s42, s41, 2
  s_lshl_b32 s42, s42, 2
  s_add_u32 s5, s5, s42
  s_and_b32 s6, s40, 1
  s_lshl_b32 s6, s6, 3
  s_lshr_b32 s42, s41, 2
  s_add_u32 s6, s6, s42
  s_and_b32 s4, s3, 3
  s_lshl_b32 s7, s5, 2
  s_add_u32 s7, s7, s4
  v_and_b32 v2, 15, v1
  v_lshrrev_b32 v3, 4, v1
  v_lshrrev_b32 v6, 1, v2
  v_xor_b32 v6, v6, v3
  v_lshlrev_b32 v6, 4, v6
  v_lshl_add_u32 v4, v2, 7, v6
  v_xor_b32 v5, 64, v4
  s_cmp_ge_u32 s3, 4
  s_cbranch_scc1 L1_B
  s_cmp_eq_u32 s4, 3
  s_cselect_b32 s8, 0, s4
  s_lshl_b32 s40, s4, 12
  v_add_u32 v140, s40, v4
  v_add_u32 v141, s40, v5
  v_lshrrev_b32 v6, 2, v2
  v_lshl_add_u32 v6, v3, 3, v6
  v_mul_u32_u24 v6, 192, v6
  v_and_b32 v7, 1, v2
  v_lshl_add_u32 v6, v7, 3, v6
  v_lshrrev_b32 v7, 1, v2
  v_and_b32 v7, 1, v7
  v_and_b32 v8, 1, v3
  v_lshlrev_b32 v8, 1, v8
  v_xor_b32 v7, v7, v8
  v_lshl_add_u32 v6, v7, 4, v6
  v_xor_b32 v7, 32, v6
  s_add_u32 s40, s8, 0
  s_cmp_ge_u32 s40, 3
  s_cselect_b32 s41, 3, 0
  s_sub_u32 s40, s40, s41
  s_mov_b32 s44, s40
  s_lshl_b32 s40, s40, 6
  s_add_u32 s40, s40, 65536
  v_add_u32 v142, s40, v6
  v_add_u32 v143, s40, v7
  s_add_u32 s40, s8, 1
  s_cmp_ge_u32 s40, 3
  s_cselect_b32 s41, 3, 0
  s_sub_u32 s40, s40, s41
  s_mov_b32 s45, s40
  s_lshl_b32 s40, s40, 6
  s_add_u32 s40, s40, 65536
  v_add_u32 v144, s40, v6
  v_add_u32 v145, s40, v7
  s_add_u32 s40, s8, 2
  s_cmp_ge_u32 s40, 3
  s_cselect_b32 s41, 3, 0
  s_sub_u32 s40, s40, s41
  s_mov_b32 s46, s40
  s_lshl_b32 s40, s40, 6
  s_add_u32 s40, s40, 65536
  v_add_u32 v146, s40, v6
  v_add_u32 v147, s40, v7
  v_mov_b32 v16, 0
  v_mov_b32 v17, 0
  v_mov_b32 v18, 0
  v_mov_b32 v19, 0
  v_mov_b32 v20, 0
  v_mov_b32 v21, 0
  v_mov_b32 v22, 0
  v_mov_b32 v23, 0
  v_mov_b32 v24, 0
  v_mov_b32 v25, 0
  v_mov_b32 v26, 0
  v_mov_b32 v27, 0
  v_mov_b32 v28, 0
  v_mov_b32 v29, 0
  v_mov_b32 v30, 0
  v_mov_b32 v31, 0
  v_mov_b32 v32, 0
  v_mov_b32 v33, 0
  v_mov_b32 v34, 0
  v_mov_b32 v35, 0
  v_mov_b32 v36, 0
  v_mov_b32 v37, 0
  v_mov_b32 v38, 0
  v_mov_b32 v39, 0
  v_mov_b32 v40, 0
  v_mov_b32 v41, 0
  v_mov_b32 v42, 0
  v_mov_b32 v43, 0
  v_mov_b32 v44, 0
  v_mov_b32 v45, 0
  v_mov_b32 v46, 0
  v_mov_b32 v47, 0
  v_mov_b32 v48, 0
  v_mov_b32 v49, 0
  v_mov_b32 v50, 0
  v_mov_b32 v51, 0
  v_mov_b32 v52, 0
  v_mov_b32 v53, 0
  v_mov_b32 v54, 0
  v_mov_b32 v55, 0
  v_mov_b32 v56, 0
  v_mov_b32 v57, 0
  v_mov_b32 v58, 0
  v_mov_b32 v59, 0
  v_mov_b32 v60, 0
  v_mov_b32 v61, 0
  v_mov_b32 v62, 0
  v_mov_b32 v63, 0
  v_mov_b32 v64, 0
  v_mov_b32 v65, 0
  v_mov_b32 v66, 0
  v_mov_b32 v67, 0
  v_mov_b32 v68, 0
  v_mov_b32 v69, 0
  v_mov_b32 v70, 0
  v_mov_b32 v71, 0
  v_mov_b32 v136, 0x3f803f80
  v_mov_b32 v137, 0x3f803f80
  v_mov_b32 v138, 0x3f803f80
  v_mov_b32 v139, 0x3f803f80
  s_barrier
  ds_read_b128 v[72:75], v140 offset:0
  ds_read_b128 v[76:79], v140 offset:2048
  ds_read_b64_tr_b16 v[80:81], v142 offset:0
  ds_read_b64_tr_b16 v[82:83], v142 offset:768
  ds_read_b64_tr_b16 v[84:85], v143 offset:0
  ds_read_b64_tr_b16 v[86:87], v143 offset:768
  ds_read_b64_tr_b16 v[88:89], v144 offset:0
  ds_read_b64_tr_b16 v[90:91], v144 offset:768
  ds_read_b64_tr_b16 v[92:93], v145 offset:0
  ds_read_b64_tr_b16 v[94:95], v145 offset:768
  ds_read_b64_tr_b16 v[96:97], v146 offset:0
  ds_read_b64_tr_b16 v[98:99], v146 offset:768
  ds_read_b64_tr_b16 v[100:101], v147 offset:0
  ds_read_b64_tr_b16 v[102:103], v147 offset:768
  s_waitcnt lgkmcnt(0)
  v_mfma_f32_16x16x32_bf16 v[16:19], v[80:83], v[72:75], v[16:19]
  ds_read_b128 v[104:107], v141 offset:0
  ds_read_b128 v[108:111], v141 offset:2048
  v_mfma_f32_16x16x32_bf16 v[40:43], v[80:83], v[76:79], v[40:43]
  ds_read_b64_tr_b16 v[112:113], v142 offset:6144
  ds_read_b64_tr_b16 v[114:115], v142 offset:6912
  v_mfma_f32_16x16x32_bf16 v[64:67], v[80:83], v[136:139], v[64:67]
  ds_read_b64_tr_b16 v[116:117], v143 offset:6144
  ds_read_b64_tr_b16 v[118:119], v143 offset:6912
  v_mfma_f32_16x16x32_bf16 v[20:23], v[84:87], v[72:75], v[20:23]
  ds_read_b64_tr_b16 v[120:121], v144 offset:6144
  ds_read_b64_tr_b16 v[122:123], v144 offset:6912
  v_mfma_f32_16x16x32_bf16 v[44:47], v[84:87], v[76:79], v[44:47]
  ds_read_b64_tr_b16 v[124:125], v145 offset:6144
  ds_read_b64_tr_b16 v[126:127], v145 offset:6912
  v_mfma_f32_16x16x32_bf16 v[68:71], v[84:87], v[136:139], v[68:71]
  ds_read_b64_tr_b16 v[128:129], v146 offset:6144
  ds_read_b64_tr_b16 v[130:131], v146 offset:6912
  v_mfma_f32_16x16x32_bf16 v[24:27], v[88:91], v[72:75], v[24:27]
  ds_read_b64_tr_b16 v[132:133], v147 offset:6144
  ds_read_b64_tr_b16 v[134:135], v147 offset:6912
  v_mfma_f32_16x16x32_bf16 v[48:51], v[88:91], v[76:79], v[48:51]
  v_mfma_f32_16x16x32_bf16 v[28:31], v[92:95], v[72:75], v[28:31]
  v_mfma_f32_16x16x32_bf16 v[52:55], v[92:95], v[76:79], v[52:55]
  v_mfma_f32_16x16x32_bf16 v[32:35], v[96:99], v[72:75], v[32:35]
  v_mfma_f32_16x16x32_bf16 v[56:59], v[96:99], v[76:79], v[56:59]
  v_mfma_f32_16x16x32_bf16 v[36:39], v[100:103], v[72:75], v[36:39]
  v_mfma_f32_16x16x32_bf16 v[60:63], v[100:103], v[76:79], v[60:63]
  s_waitcnt lgkmcnt(0)
  s_barrier
  v_mfma_f32_16x16x32_bf16 v[16:19], v[112:115], v[104:107], v[16:19]
  ds_read_b128 v[72:75], v140 offset:16384
  ds_read_b128 v[76:79], v140 offset:18432
  v_mfma_f32_16x16x32_bf16 v[40:43], v[112:115], v[108:111], v[40:43]
  ds_read_b64_tr_b16 v[80:81], v142 offset:12288
  ds_read_b64_tr_b16 v[82:83], v142 offset:13056
  v_mfma_f32_16x16x32_bf16 v[64:67], v[112:115], v[136:139], v[64:67]
  ds_read_b64_tr_b16 v[84:85], v143 offset:12288
  ds_read_b64_tr_b16 v[86:87], v143 offset:13056
  v_mfma_f32_16x16x32_bf16 v[20:23], v[116:119], v[104:107], v[20:23]
  ds_read_b64_tr_b16 v[88:89], v144 offset:12288
  ds_read_b64_tr_b16 v[90:91], v144 offset:13056
  v_mfma_f32_16x16x32_bf16 v[44:47], v[116:119], v[108:111], v[44:47]
  ds_read_b64_tr_b16 v[92:93], v145 offset:12288
  ds_read_b64_tr_b16 v[94:95], v145 offset:13056
  v_mfma_f32_16x16x32_bf16 v[68:71], v[116:119], v[136:139], v[68:71]
  ds_read_b64_tr_b16 v[96:97], v146 offset:12288
  ds_read_b64_tr_b16 v[98:99], v146 offset:13056
  v_mfma_f32_16x16x32_bf16 v[24:27], v[120:123], v[104:107], v[24:27]
  ds_read_b64_tr_b16 v[100:101], v147 offset:12288
  ds_read_b64_tr_b16 v[102:103], v147 offset:13056
  v_mfma_f32_16x16x32_bf16 v[48:51], v[120:123], v[108:111], v[48:51]
  v_mfma_f32_16x16x32_bf16 v[28:31], v[124:127], v[104:107], v[28:31]
  v_mfma_f32_16x16x32_bf16 v[52:55], v[124:127], v[108:111], v[52:55]
  v_mfma_f32_16x16x32_bf16 v[32:35], v[128:131], v[104:107], v[32:35]
  v_mfma_f32_16x16x32_bf16 v[56:59], v[128:131], v[108:111], v[56:59]
  v_mfma_f32_16x16x32_bf16 v[36:39], v[132:135], v[104:107], v[36:39]
  v_mfma_f32_16x16x32_bf16 v[60:63], v[132:135], v[108:111], v[60:63]
  s_waitcnt lgkmcnt(0)
  v_mfma_f32_16x16x32_bf16 v[16:19], v[80:83], v[72:75], v[16:19]
  ds_read_b128 v[104:107], v141 offset:16384
  ds_read_b128 v[108:111], v141 offset:18432
  v_mfma_f32_16x16x32_bf16 v[40:43], v[80:83], v[76:79], v[40:43]
  ds_read_b64_tr_b16 v[112:113], v142 offset:18432
  ds_read_b64_tr_b16 v[114:115], v142 offset:19200
  v_mfma_f32_16x16x32_bf16 v[64:67], v[80:83], v[136:139], v[64:67]
  ds_read_b64_tr_b16 v[116:117], v143 offset:18432
  ds_read_b64_tr_b16 v[118:119], v143 offset:19200
  v_mfma_f32_16x16x32_bf16 v[20:23], v[84:87], v[72:75], v[20:23]
  ds_read_b64_tr_b16 v[120:121], v144 offset:18432
  ds_read_b64_tr_b16 v[122:123], v144 offset:19200
  v_mfma_f32_16x16x32_bf16 v[44:47], v[84:87], v[76:79], v[44:47]
  ds_read_b64_tr_b16 v[124:125], v145 offset:18432
  ds_read_b64_tr_b16 v[126:127], v145 offset:19200
  v_mfma_f32_16x16x32_bf16 v[68:71], v[84:87], v[136:139], v[68:71]
  ds_read_b64_tr_b16 v[128:129], v146 offset:18432
  ds_read_b64_tr_b16 v[130:131], v146 offset:19200
  v_mfma_f32_16x16x32_bf16 v[24:27], v[88:91], v[72:75], v[24:27]
  ds_read_b64_tr_b16 v[132:133], v147 offset:18432
  ds_read_b64_tr_b16 v[134:135], v147 offset:19200
  v_mfma_f32_16x16x32_bf16 v[48:51], v[88:91], v[76:79], v[48:51]
  v_mfma_f32_16x16x32_bf16 v[28:31], v[92:95], v[72:75], v[28:31]
  v_mfma_f32_16x16x32_bf16 v[52:55], v[92:95], v[76:79], v[52:55]
  v_mfma_f32_16x16x32_bf16 v[32:35], v[96:99], v[72:75], v[32:35]
  v_mfma_f32_16x16x32_bf16 v[56:59], v[96:99], v[76:79], v[56:59]
  v_mfma_f32_16x16x32_bf16 v[36:39], v[100:103], v[72:75], v[36:39]
  v_mfma_f32_16x16x32_bf16 v[60:63], v[100:103], v[76:79], v[60:63]
  s_waitcnt lgkmcnt(0)
  s_barrier
  v_mfma_f32_16x16x32_bf16 v[16:19], v[112:115], v[104:107], v[16:19]
  ds_read_b128 v[72:75], v140 offset:32768
  ds_read_b128 v[76:79], v140 offset:34816
  v_mfma_f32_16x16x32_bf16 v[40:43], v[112:115], v[108:111], v[40:43]
  ds_read_b64_tr_b16 v[80:81], v142 offset:24576
  ds_read_b64_tr_b16 v[82:83], v142 offset:25344
  v_mfma_f32_16x16x32_bf16 v[64:67], v[112:115], v[136:139], v[64:67]
  ds_read_b64_tr_b16 v[84:85], v143 offset:24576
  ds_read_b64_tr_b16 v[86:87], v143 offset:25344
  v_mfma_f32_16x16x32_bf16 v[20:23], v[116:119], v[104:107], v[20:23]
  ds_read_b64_tr_b16 v[88:89], v144 offset:24576
  ds_read_b64_tr_b16 v[90:91], v144 offset:25344
  v_mfma_f32_16x16x32_bf16 v[44:47], v[116:119], v[108:111], v[44:47]
  ds_read_b64_tr_b16 v[92:93], v145 offset:24576
  ds_read_b64_tr_b16 v[94:95], v145 offset:25344
  v_mfma_f32_16x16x32_bf16 v[68:71], v[116:119], v[136:139], v[68:71]
  ds_read_b64_tr_b16 v[96:97], v146 offset:24576
  ds_read_b64_tr_b16 v[98:99], v146 offset:25344
  v_mfma_f32_16x16x32_bf16 v[24:27], v[120:123], v[104:107], v[24:27]
  ds_read_b64_tr_b16 v[100:101], v147 offset:24576
  ds_read_b64_tr_b16 v[102:103], v147 offset:25344
  v_mfma_f32_16x16x32_bf16 v[48:51], v[120:123], v[108:111], v[48:51]
  v_mfma_f32_16x16x32_bf16 v[28:31], v[124:127], v[104:107], v[28:31]
  v_mfma_f32_16x16x32_bf16 v[52:55], v[124:127], v[108:111], v[52:55]
  v_mfma_f32_16x16x32_bf16 v[32:35], v[128:131], v[104:107], v[32:35]
  v_mfma_f32_16x16x32_bf16 v[56:59], v[128:131], v[108:111], v[56:59]
  v_mfma_f32_16x16x32_bf16 v[36:39], v[132:135], v[104:107], v[36:39]
  v_mfma_f32_16x16x32_bf16 v[60:63], v[132:135], v[108:111], v[60:63]
  s_waitcnt lgkmcnt(0)
  v_mfma_f32_16x16x32_bf16 v[16:19], v[80:83], v[72:75], v[16:19]
  ds_read_b128 v[104:107], v141 offset:32768
  ds_read_b128 v[108:111], v141 offset:34816
  v_mfma_f32_16x16x32_bf16 v[40:43], v[80:83], v[76:79], v[40:43]
  ds_read_b64_tr_b16 v[112:113], v142 offset:30720
  ds_read_b64_tr_b16 v[114:115], v142 offset:31488
  v_mfma_f32_16x16x32_bf16 v[64:67], v[80:83], v[136:139], v[64:67]
  ds_read_b64_tr_b16 v[116:117], v143 offset:30720
  ds_read_b64_tr_b16 v[118:119], v143 offset:31488
  v_mfma_f32_16x16x32_bf16 v[20:23], v[84:87], v[72:75], v[20:23]
  ds_read_b64_tr_b16 v[120:121], v144 offset:30720
  ds_read_b64_tr_b16 v[122:123], v144 offset:31488
  v_mfma_f32_16x16x32_bf16 v[44:47], v[84:87], v[76:79], v[44:47]
  ds_read_b64_tr_b16 v[124:125], v145 offset:30720
  ds_read_b64_tr_b16 v[126:127], v145 offset:31488
  v_mfma_f32_16x16x32_bf16 v[68:71], v[84:87], v[136:139], v[68:71]
  ds_read_b64_tr_b16 v[128:129], v146 offset:30720
  ds_read_b64_tr_b16 v[130:131], v146 offset:31488
  v_mfma_f32_16x16x32_bf16 v[24:27], v[88:91], v[72:75], v[24:27]
  ds_read_b64_tr_b16 v[132:133], v147 offset:30720
  ds_read_b64_tr_b16 v[134:135], v147 offset:31488
  v_mfma_f32_16x16x32_bf16 v[48:51], v[88:91], v[76:79], v[48:51]
  v_mfma_f32_16x16x32_bf16 v[28:31], v[92:95], v[72:75], v[28:31]
  v_mfma_f32_16x16x32_bf16 v[52:55], v[92:95], v[76:79], v[52:55]
  v_mfma_f32_16x16x32_bf16 v[32:35], v[96:99], v[72:75], v[32:35]
  v_mfma_f32_16x16x32_bf16 v[56:59], v[96:99], v[76:79], v[56:59]
  v_mfma_f32_16x16x32_bf16 v[36:39], v[100:103], v[72:75], v[36:39]
  v_mfma_f32_16x16x32_bf16 v[60:63], v[100:103], v[76:79], v[60:63]
  s_waitcnt lgkmcnt(0)
  s_barrier
  v_mfma_f32_16x16x32_bf16 v[16:19], v[112:115], v[104:107], v[16:19]
  ds_read_b128 v[72:75], v140 offset:49152
  ds_read_b128 v[76:79], v140 offset:51200
  v_mfma_f32_16x16x32_bf16 v[40:43], v[112:115], v[108:111], v[40:43]
  ds_read_b64_tr_b16 v[80:81], v142 offset:36864
  ds_read_b64_tr_b16 v[82:83], v142 offset:37632
  v_mfma_f32_16x16x32_bf16 v[64:67], v[112:115], v[136:139], v[64:67]
  ds_read_b64_tr_b16 v[84:85], v143 offset:36864
  ds_read_b64_tr_b16 v[86:87], v143 offset:37632
  v_mfma_f32_16x16x32_bf16 v[20:23], v[116:119], v[104:107], v[20:23]
  ds_read_b64_tr_b16 v[88:89], v144 offset:36864
  ds_read_b64_tr_b16 v[90:91], v144 offset:37632
  v_mfma_f32_16x16x32_bf16 v[44:47], v[116:119], v[108:111], v[44:47]
  ds_read_b64_tr_b16 v[92:93], v145 offset:36864
  ds_read_b64_tr_b16 v[94:95], v145 offset:37632
  v_mfma_f32_16x16x32_bf16 v[68:71], v[116:119], v[136:139], v[68:71]
  ds_read_b64_tr_b16 v[96:97], v146 offset:36864
  ds_read_b64_tr_b16 v[98:99], v146 offset:37632
  v_mfma_f32_16x16x32_bf16 v[24:27], v[120:123], v[104:107], v[24:27]
  ds_read_b64_tr_b16 v[100:101], v147 offset:36864
  ds_read_b64_tr_b16 v[102:103], v147 offset:37632
  v_mfma_f32_16x16x32_bf16 v[48:51], v[120:123], v[108:111], v[48:51]
  v_mfma_f32_16x16x32_bf16 v[28:31], v[124:127], v[104:107], v[28:31]
  v_mfma_f32_16x16x32_bf16 v[52:55], v[124:127], v[108:111], v[52:55]
  v_mfma_f32_16x16x32_bf16 v[32:35], v[128:131], v[104:107], v[32:35]
  v_mfma_f32_16x16x32_bf16 v[56:59], v[128:131], v[108:111], v[56:59]
  v_mfma_f32_16x16x32_bf16 v[36:39], v[132:135], v[104:107], v[36:39]
  v_mfma_f32_16x16x32_bf16 v[60:63], v[132:135], v[108:111], v[60:63]
  s_waitcnt lgkmcnt(0)
  v_mfma_f32_16x16x32_bf16 v[16:19], v[80:83], v[72:75], v[16:19]
  ds_read_b128 v[104:107], v141 offset:49152
  ds_read_b128 v[108:111], v141 offset:51200
  v_mfma_f32_16x16x32_bf16 v[40:43], v[80:83], v[76:79], v[40:43]
  ds_read_b64_tr_b16 v[112:113], v142 offset:43008
  ds_read_b64_tr_b16 v[114:115], v142 offset:43776
  v_mfma_f32_16x16x32_bf16 v[64:67], v[80:83], v[136:139], v[64:67]
  ds_read_b64_tr_b16 v[116:117], v143 offset:43008
  ds_read_b64_tr_b16 v[118:119], v143 offset:43776
  v_mfma_f32_16x16x32_bf16 v[20:23], v[84:87], v[72:75], v[20:23]
  ds_read_b64_tr_b16 v[120:121], v144 offset:43008
  ds_read_b64_tr_b16 v[122:123], v144 offset:43776
  v_mfma_f32_16x16x32_bf16 v[44:47], v[84:87], v[76:79], v[44:47]
  ds_read_b64_tr_b16 v[124:125], v145 offset:43008
  ds_read_b64_tr_b16 v[126:127], v145 offset:43776
  v_mfma_f32_16x16x32_bf16 v[68:71], v[84:87], v[136:139], v[68:71]
  ds_read_b64_tr_b16 v[128:129], v146 offset:43008
  ds_read_b64_tr_b16 v[130:131], v146 offset:43776
  v_mfma_f32_16x16x32_bf16 v[24:27], v[88:91], v[72:75], v[24:27]
  ds_read_b64_tr_b16 v[132:133], v147 offset:43008
  ds_read_b64_tr_b16 v[134:135], v147 offset:43776
  v_mfma_f32_16x16x32_bf16 v[48:51], v[88:91], v[76:79], v[48:51]
  v_mfma_f32_16x16x32_bf16 v[28:31], v[92:95], v[72:75], v[28:31]
  v_mfma_f32_16x16x32_bf16 v[52:55], v[92:95], v[76:79], v[52:55]
  v_mfma_f32_16x16x32_bf16 v[32:35], v[96:99], v[72:75], v[32:35]
  v_mfma_f32_16x16x32_bf16 v[56:59], v[96:99], v[76:79], v[56:59]
  v_mfma_f32_16x16x32_bf16 v[36:39], v[100:103], v[72:75], v[36:39]
  v_mfma_f32_16x16x32_bf16 v[60:63], v[100:103], v[76:79], v[60:63]
  s_waitcnt lgkmcnt(0)
  s_barrier
  v_mfma_f32_16x16x32_bf16 v[16:19], v[112:115], v[104:107], v[16:19]
  ds_read_b128 v[72:75], v140 offset:0
  ds_read_b128 v[76:79], v140 offset:2048
  v_mfma_f32_16x16x32_bf16 v[40:43], v[112:115], v[108:111], v[40:43]
  ds_read_b64_tr_b16 v[80:81], v142 offset:0
  ds_read_b64_tr_b16 v[82:83], v142 offset:768
  v_mfma_f32_16x16x32_bf16 v[64:67], v[112:115], v[136:139], v[64:67]
  ds_read_b64_tr_b16 v[84:85], v143 offset:0
  ds_read_b64_tr_b16 v[86:87], v143 offset:768
  v_mfma_f32_16x16x32_bf16 v[20:23], v[116:119], v[104:107], v[20:23]
  ds_read_b64_tr_b16 v[88:89], v144 offset:0
  ds_read_b64_tr_b16 v[90:91], v144 offset:768
  v_mfma_f32_16x16x32_bf16 v[44:47], v[116:119], v[108:111], v[44:47]
  ds_read_b64_tr_b16 v[92:93], v145 offset:0
  ds_read_b64_tr_b16 v[94:95], v145 offset:768
  v_mfma_f32_16x16x32_bf16 v[68:71], v[116:119], v[136:139], v[68:71]
  ds_read_b64_tr_b16 v[96:97], v146 offset:0
  ds_read_b64_tr_b16 v[98:99], v146 offset:768
  v_mfma_f32_16x16x32_bf16 v[24:27], v[120:123], v[104:107], v[24:27]
  ds_read_b64_tr_b16 v[100:101], v147 offset:0
  ds_read_b64_tr_b16 v[102:103], v147 offset:768
  v_mfma_f32_16x16x32_bf16 v[48:51], v[120:123], v[108:111], v[48:51]
  v_mfma_f32_16x16x32_bf16 v[28:31], v[124:127], v[104:107], v[28:31]
  v_mfma_f32_16x16x32_bf16 v[52:55], v[124:127], v[108:111], v[52:55]
  v_mfma_f32_16x16x32_bf16 v[32:35], v[128:131], v[104:107], v[32:35]
  v_mfma_f32_16x16x32_bf16 v[56:59], v[128:131], v[108:111], v[56:59]
  v_mfma_f32_16x16x32_bf16 v[36:39], v[132:135], v[104:107], v[36:39]
  v_mfma_f32_16x16x32_bf16 v[60:63], v[132:135], v[108:111], v[60:63]
  s_waitcnt lgkmcnt(0)
  v_mfma_f32_16x16x32_bf16 v[16:19], v[80:83], v[72:75], v[16:19]
  ds_read_b128 v[104:107], v141 offset:0
  ds_read_b128 v[108:111], v141 offset:2048
  v_mfma_f32_16x16x32_bf16 v[40:43], v[80:83], v[76:79], v[40:43]
  ds_read_b64_tr_b16 v[112:113], v142 offset:6144
  ds_read_b64_tr_b16 v[114:115], v142 offset:6912
  v_mfma_f32_16x16x32_bf16 v[64:67], v[80:83], v[136:139], v[64:67]
  ds_read_b64_tr_b16 v[116:117], v143 offset:6144
  ds_read_b64_tr_b16 v[118:119], v143 offset:6912
  v_mfma_f32_16x16x32_bf16 v[20:23], v[84:87], v[72:75], v[20:23]
  ds_read_b64_tr_b16 v[120:121], v144 offset:6144
  ds_read_b64_tr_b16 v[122:123], v144 offset:6912
  v_mfma_f32_16x16x32_bf16 v[44:47], v[84:87], v[76:79], v[44:47]
  ds_read_b64_tr_b16 v[124:125], v145 offset:6144
  ds_read_b64_tr_b16 v[126:127], v145 offset:6912
  v_mfma_f32_16x16x32_bf16 v[68:71], v[84:87], v[136:139], v[68:71]
  ds_read_b64_tr_b16 v[128:129], v146 offset:6144
  ds_read_b64_tr_b16 v[130:131], v146 offset:6912
  v_mfma_f32_16x16x32_bf16 v[24:27], v[88:91], v[72:75], v[24:27]
  ds_read_b64_tr_b16 v[132:133], v147 offset:6144
  ds_read_b64_tr_b16 v[134:135], v147 offset:6912
  v_mfma_f32_16x16x32_bf16 v[48:51], v[88:91], v[76:79], v[48:51]
  v_mfma_f32_16x16x32_bf16 v[28:31], v[92:95], v[72:75], v[28:31]
  v_mfma_f32_16x16x32_bf16 v[52:55], v[92:95], v[76:79], v[52:55]
  v_mfma_f32_16x16x32_bf16 v[32:35], v[96:99], v[72:75], v[32:35]
  v_mfma_f32_16x16x32_bf16 v[56:59], v[96:99], v[76:79], v[56:59]
  v_mfma_f32_16x16x32_bf16 v[36:39], v[100:103], v[72:75], v[36:39]
  v_mfma_f32_16x16x32_bf16 v[60:63], v[100:103], v[76:79], v[60:63]
  s_waitcnt lgkmcnt(0)
  s_barrier
  v_mfma_f32_16x16x32_bf16 v[16:19], v[112:115], v[104:107], v[16:19]
  ds_read_b128 v[72:75], v140 offset:16384
  ds_read_b128 v[76:79], v140 offset:18432
  v_mfma_f32_16x16x32_bf16 v[40:43], v[112:115], v[108:111], v[40:43]
  ds_read_b64_tr_b16 v[80:81], v142 offset:12288
  ds_read_b64_tr_b16 v[82:83], v142 offset:13056
  v_mfma_f32_16x16x32_bf16 v[64:67], v[112:115], v[136:139], v[64:67]
  ds_read_b64_tr_b16 v[84:85], v143 offset:12288
  ds_read_b64_tr_b16 v[86:87], v143 offset:13056
  v_mfma_f32_16x16x32_bf16 v[20:23], v[116:119], v[104:107], v[20:23]
  ds_read_b64_tr_b16 v[88:89], v144 offset:12288
  ds_read_b64_tr_b16 v[90:91], v144 offset:13056
  v_mfma_f32_16x16x32_bf16 v[44:47], v[116:119], v[108:111], v[44:47]
  ds_read_b64_tr_b16 v[92:93], v145 offset:12288
  ds_read_b64_tr_b16 v[94:95], v145 offset:13056
  v_mfma_f32_16x16x32_bf16 v[68:71], v[116:119], v[136:139], v[68:71]
  ds_read_b64_tr_b16 v[96:97], v146 offset:12288
  ds_read_b64_tr_b16 v[98:99], v146 offset:13056
  v_mfma_f32_16x16x32_bf16 v[24:27], v[120:123], v[104:107], v[24:27]
  ds_read_b64_tr_b16 v[100:101], v147 offset:12288
  ds_read_b64_tr_b16 v[102:103], v147 offset:13056
  v_mfma_f32_16x16x32_bf16 v[48:51], v[120:123], v[108:111], v[48:51]
  v_mfma_f32_16x16x32_bf16 v[28:31], v[124:127], v[104:107], v[28:31]
  v_mfma_f32_16x16x32_bf16 v[52:55], v[124:127], v[108:111], v[52:55]
  v_mfma_f32_16x16x32_bf16 v[32:35], v[128:131], v[104:107], v[32:35]
  v_mfma_f32_16x16x32_bf16 v[56:59], v[128:131], v[108:111], v[56:59]
  v_mfma_f32_16x16x32_bf16 v[36:39], v[132:135], v[104:107], v[36:39]
  v_mfma_f32_16x16x32_bf16 v[60:63], v[132:135], v[108:111], v[60:63]
  s_waitcnt lgkmcnt(0)
  v_mfma_f32_16x16x32_bf16 v[16:19], v[80:83], v[72:75], v[16:19]
  ds_read_b128 v[104:107], v141 offset:16384
  ds_read_b128 v[108:111], v141 offset:18432
  v_mfma_f32_16x16x32_bf16 v[40:43], v[80:83], v[76:79], v[40:43]
  ds_read_b64_tr_b16 v[112:113], v142 offset:18432
  ds_read_b64_tr_b16 v[114:115], v142 offset:19200
  v_mfma_f32_16x16x32_bf16 v[64:67], v[80:83], v[136:139], v[64:67]
  ds_read_b64_tr_b16 v[116:117], v143 offset:18432
  ds_read_b64_tr_b16 v[118:119], v143 offset:19200
  v_mfma_f32_16x16x32_bf16 v[20:23], v[84:87], v[72:75], v[20:23]
  ds_read_b64_tr_b16 v[120:121], v144 offset:18432
  ds_read_b64_tr_b16 v[122:123], v144 offset:19200
  v_mfma_f32_16x16x32_bf16 v[44:47], v[84:87], v[76:79], v[44:47]
  ds_read_b64_tr_b16 v[124:125], v145 offset:18432
  ds_read_b64_tr_b16 v[126:127], v145 offset:19200
  v_mfma_f32_16x16x32_bf16 v[68:71], v[84:87], v[136:139], v[68:71]
  ds_read_b64_tr_b16 v[128:129], v146 offset:18432
  ds_read_b64_tr_b16 v[130:131], v146 offset:19200
  v_mfma_f32_16x16x32_bf16 v[24:27], v[88:91], v[72:75], v[24:27]
  ds_read_b64_tr_b16 v[132:133], v147 offset:18432
  ds_read_b64_tr_b16 v[134:135], v147 offset:19200
  v_mfma_f32_16x16x32_bf16 v[48:51], v[88:91], v[76:79], v[48:51]
  v_mfma_f32_16x16x32_bf16 v[28:31], v[92:95], v[72:75], v[28:31]
  v_mfma_f32_16x16x32_bf16 v[52:55], v[92:95], v[76:79], v[52:55]
  v_mfma_f32_16x16x32_bf16 v[32:35], v[96:99], v[72:75], v[32:35]
  v_mfma_f32_16x16x32_bf16 v[56:59], v[96:99], v[76:79], v[56:59]
  v_mfma_f32_16x16x32_bf16 v[36:39], v[100:103], v[72:75], v[36:39]
  v_mfma_f32_16x16x32_bf16 v[60:63], v[100:103], v[76:79], v[60:63]
  s_waitcnt lgkmcnt(0)
  s_barrier
  v_mfma_f32_16x16x32_bf16 v[16:19], v[112:115], v[104:107], v[16:19]
  ds_read_b128 v[72:75], v140 offset:32768
  ds_read_b128 v[76:79], v140 offset:34816
  v_mfma_f32_16x16x32_bf16 v[40:43], v[112:115], v[108:111], v[40:43]
  ds_read_b64_tr_b16 v[80:81], v142 offset:24576
  ds_read_b64_tr_b16 v[82:83], v142 offset:25344
  v_mfma_f32_16x16x32_bf16 v[64:67], v[112:115], v[136:139], v[64:67]
  ds_read_b64_tr_b16 v[84:85], v143 offset:24576
  ds_read_b64_tr_b16 v[86:87], v143 offset:25344
  v_mfma_f32_16x16x32_bf16 v[20:23], v[116:119], v[104:107], v[20:23]
  ds_read_b64_tr_b16 v[88:89], v144 offset:24576
  ds_read_b64_tr_b16 v[90:91], v144 offset:25344
  v_mfma_f32_16x16x32_bf16 v[44:47], v[116:119], v[108:111], v[44:47]
  ds_read_b64_tr_b16 v[92:93], v145 offset:24576
  ds_read_b64_tr_b16 v[94:95], v145 offset:25344
  v_mfma_f32_16x16x32_bf16 v[68:71], v[116:119], v[136:139], v[68:71]
  ds_read_b64_tr_b16 v[96:97], v146 offset:24576
  ds_read_b64_tr_b16 v[98:99], v146 offset:25344
  v_mfma_f32_16x16x32_bf16 v[24:27], v[120:123], v[104:107], v[24:27]
  ds_read_b64_tr_b16 v[100:101], v147 offset:24576
  ds_read_b64_tr_b16 v[102:103], v147 offset:25344
  v_mfma_f32_16x16x32_bf16 v[48:51], v[120:123], v[108:111], v[48:51]
  v_mfma_f32_16x16x32_bf16 v[28:31], v[124:127], v[104:107], v[28:31]
  v_mfma_f32_16x16x32_bf16 v[52:55], v[124:127], v[108:111], v[52:55]
  v_mfma_f32_16x16x32_bf16 v[32:35], v[128:131], v[104:107], v[32:35]
  v_mfma_f32_16x16x32_bf16 v[56:59], v[128:131], v[108:111], v[56:59]
  v_mfma_f32_16x16x32_bf16 v[36:39], v[132:135], v[104:107], v[36:39]
  v_mfma_f32_16x16x32_bf16 v[60:63], v[132:135], v[108:111], v[60:63]
  s_waitcnt lgkmcnt(0)
  v_mfma_f32_16x16x32_bf16 v[16:19], v[80:83], v[72:75], v[16:19]
  ds_read_b128 v[104:107], v141 offset:32768
  ds_read_b128 v[108:111], v141 offset:34816
  v_mfma_f32_16x16x32_bf16 v[40:43], v[80:83], v[76:79], v[40:43]
  ds_read_b64_tr_b16 v[112:113], v142 offset:30720
  ds_read_b64_tr_b16 v[114:115], v142 offset:31488
  v_mfma_f32_16x16x32_bf16 v[64:67], v[80:83], v[136:139], v[64:67]
  ds_read_b64_tr_b16 v[116:117], v143 offset:30720
  ds_read_b64_tr_b16 v[118:119], v143 offset:31488
  v_mfma_f32_16x16x32_bf16 v[20:23], v[84:87], v[72:75], v[20:23]
  ds_read_b64_tr_b16 v[120:121], v144 offset:30720
  ds_read_b64_tr_b16 v[122:123], v144 offset:31488
  v_mfma_f32_16x16x32_bf16 v[44:47], v[84:87], v[76:79], v[44:47]
  ds_read_b64_tr_b16 v[124:125], v145 offset:30720
  ds_read_b64_tr_b16 v[126:127], v145 offset:31488
  v_mfma_f32_16x16x32_bf16 v[68:71], v[84:87], v[136:139], v[68:71]
  ds_read_b64_tr_b16 v[128:129], v146 offset:30720
  ds_read_b64_tr_b16 v[130:131], v146 offset:31488
  v_mfma_f32_16x16x32_bf16 v[24:27], v[88:91], v[72:75], v[24:27]
  ds_read_b64_tr_b16 v[132:133], v147 offset:30720
  ds_read_b64_tr_b16 v[134:135], v147 offset:31488
  v_mfma_f32_16x16x32_bf16 v[48:51], v[88:91], v[76:79], v[48:51]
  v_mfma_f32_16x16x32_bf16 v[28:31], v[92:95], v[72:75], v[28:31]
  v_mfma_f32_16x16x32_bf16 v[52:55], v[92:95], v[76:79], v[52:55]
  v_mfma_f32_16x16x32_bf16 v[32:35], v[96:99], v[72:75], v[32:35]
  v_mfma_f32_16x16x32_bf16 v[56:59], v[96:99], v[76:79], v[56:59]
  v_mfma_f32_16x16x32_bf16 v[36:39], v[100:103], v[72:75], v[36:39]
  v_mfma_f32_16x16x32_bf16 v[60:63], v[100:103], v[76:79], v[60:63]
  s_waitcnt lgkmcnt(0)
  s_barrier
  v_mfma_f32_16x16x32_bf16 v[16:19], v[112:115], v[104:107], v[16:19]
  ds_read_b128 v[72:75], v140 offset:49152
  ds_read_b128 v[76:79], v140 offset:51200
  v_mfma_f32_16x16x32_bf16 v[40:43], v[112:115], v[108:111], v[40:43]
  ds_read_b64_tr_b16 v[80:81], v142 offset:36864
  ds_read_b64_tr_b16 v[82:83], v142 offset:37632
  v_mfma_f32_16x16x32_bf16 v[64:67], v[112:115], v[136:139], v[64:67]
  ds_read_b64_tr_b16 v[84:85], v143 offset:36864
  ds_read_b64_tr_b16 v[86:87], v143 offset:37632
  v_mfma_f32_16x16x32_bf16 v[20:23], v[116:119], v[104:107], v[20:23]
  ds_read_b64_tr_b16 v[88:89], v144 offset:36864
  ds_read_b64_tr_b16 v[90:91], v144 offset:37632
  v_mfma_f32_16x16x32_bf16 v[44:47], v[116:119], v[108:111], v[44:47]
  ds_read_b64_tr_b16 v[92:93], v145 offset:36864
  ds_read_b64_tr_b16 v[94:95], v145 offset:37632
  v_mfma_f32_16x16x32_bf16 v[68:71], v[116:119], v[136:139], v[68:71]
  ds_read_b64_tr_b16 v[96:97], v146 offset:36864
  ds_read_b64_tr_b16 v[98:99], v146 offset:37632
  v_mfma_f32_16x16x32_bf16 v[24:27], v[120:123], v[104:107], v[24:27]
  ds_read_b64_tr_b16 v[100:101], v147 offset:36864
  ds_read_b64_tr_b16 v[102:103], v147 offset:37632
  v_mfma_f32_16x16x32_bf16 v[48:51], v[120:123], v[108:111], v[48:51]
  v_mfma_f32_16x16x32_bf16 v[28:31], v[124:127], v[104:107], v[28:31]
  v_mfma_f32_16x16x32_bf16 v[52:55], v[124:127], v[108:111], v[52:55]
  v_mfma_f32_16x16x32_bf16 v[32:35], v[128:131], v[104:107], v[32:35]
  v_mfma_f32_16x16x32_bf16 v[56:59], v[128:131], v[108:111], v[56:59]
  v_mfma_f32_16x16x32_bf16 v[36:39], v[132:135], v[104:107], v[36:39]
  v_mfma_f32_16x16x32_bf16 v[60:63], v[132:135], v[108:111], v[60:63]
  s_waitcnt lgkmcnt(0)
  v_mfma_f32_16x16x32_bf16 v[16:19], v[80:83], v[72:75], v[16:19]
  ds_read_b128 v[104:107], v141 offset:49152
  ds_read_b128 v[108:111], v141 offset:51200
  v_mfma_f32_16x16x32_bf16 v[40:43], v[80:83], v[76:79], v[40:43]
  ds_read_b64_tr_b16 v[112:113], v142 offset:43008
  ds_read_b64_tr_b16 v[114:115], v142 offset:43776
  v_mfma_f32_16x16x32_bf16 v[64:67], v[80:83], v[136:139], v[64:67]
  ds_read_b64_tr_b16 v[116:117], v143 offset:43008
  ds_read_b64_tr_b16 v[118:119], v143 offset:43776
  v_mfma_f32_16x16x32_bf16 v[20:23], v[84:87], v[72:75], v[20:23]
  ds_read_b64_tr_b16 v[120:121], v144 offset:43008
  ds_read_b64_tr_b16 v[122:123], v144 offset:43776
  v_mfma_f32_16x16x32_bf16 v[44:47], v[84:87], v[76:79], v[44:47]
  ds_read_b64_tr_b16 v[124:125], v145 offset:43008
  ds_read_b64_tr_b16 v[126:127], v145 offset:43776
  v_mfma_f32_16x16x32_bf16 v[68:71], v[84:87], v[136:139], v[68:71]
  ds_read_b64_tr_b16 v[128:129], v146 offset:43008
  ds_read_b64_tr_b16 v[130:131], v146 offset:43776
  v_mfma_f32_16x16x32_bf16 v[24:27], v[88:91], v[72:75], v[24:27]
  ds_read_b64_tr_b16 v[132:133], v147 offset:43008
  ds_read_b64_tr_b16 v[134:135], v147 offset:43776
  v_mfma_f32_16x16x32_bf16 v[48:51], v[88:91], v[76:79], v[48:51]
  v_mfma_f32_16x16x32_bf16 v[28:31], v[92:95], v[72:75], v[28:31]
  v_mfma_f32_16x16x32_bf16 v[52:55], v[92:95], v[76:79], v[52:55]
  v_mfma_f32_16x16x32_bf16 v[32:35], v[96:99], v[72:75], v[32:35]
  v_mfma_f32_16x16x32_bf16 v[56:59], v[96:99], v[76:79], v[56:59]
  v_mfma_f32_16x16x32_bf16 v[36:39], v[100:103], v[72:75], v[36:39]
  v_mfma_f32_16x16x32_bf16 v[60:63], v[100:103], v[76:79], v[60:63]
  s_waitcnt lgkmcnt(0)
  s_barrier
  v_mfma_f32_16x16x32_bf16 v[16:19], v[112:115], v[104:107], v[16:19]
  ds_read_b128 v[72:75], v140 offset:0
  ds_read_b128 v[76:79], v140 offset:2048
  v_mfma_f32_16x16x32_bf16 v[40:43], v[112:115], v[108:111], v[40:43]
  ds_read_b64_tr_b16 v[80:81], v142 offset:0
  ds_read_b64_tr_b16 v[82:83], v142 offset:768
  v_mfma_f32_16x16x32_bf16 v[64:67], v[112:115], v[136:139], v[64:67]
  ds_read_b64_tr_b16 v[84:85], v143 offset:0
  ds_read_b64_tr_b16 v[86:87], v143 offset:768
  v_mfma_f32_16x16x32_bf16 v[20:23], v[116:119], v[104:107], v[20:23]
  ds_read_b64_tr_b16 v[88:89], v144 offset:0
  ds_read_b64_tr_b16 v[90:91], v144 offset:768
  v_mfma_f32_16x16x32_bf16 v[44:47], v[116:119], v[108:111], v[44:47]
  ds_read_b64_tr_b16 v[92:93], v145 offset:0
  ds_read_b64_tr_b16 v[94:95], v145 offset:768
  v_mfma_f32_16x16x32_bf16 v[68:71], v[116:119], v[136:139], v[68:71]
  ds_read_b64_tr_b16 v[96:97], v146 offset:0
  ds_read_b64_tr_b16 v[98:99], v146 offset:768
  v_mfma_f32_16x16x32_bf16 v[24:27], v[120:123], v[104:107], v[24:27]
  ds_read_b64_tr_b16 v[100:101], v147 offset:0
  ds_read_b64_tr_b16 v[102:103], v147 offset:768
  v_mfma_f32_16x16x32_bf16 v[48:51], v[120:123], v[108:111], v[48:51]
  v_mfma_f32_16x16x32_bf16 v[28:31], v[124:127], v[104:107], v[28:31]
  v_mfma_f32_16x16x32_bf16 v[52:55], v[124:127], v[108:111], v[52:55]
  v_mfma_f32_16x16x32_bf16 v[32:35], v[128:131], v[104:107], v[32:35]
  v_mfma_f32_16x16x32_bf16 v[56:59], v[128:131], v[108:111], v[56:59]
  v_mfma_f32_16x16x32_bf16 v[36:39], v[132:135], v[104:107], v[36:39]
  v_mfma_f32_16x16x32_bf16 v[60:63], v[132:135], v[108:111], v[60:63]
  s_waitcnt lgkmcnt(0)
  v_mfma_f32_16x16x32_bf16 v[16:19], v[80:83], v[72:75], v[16:19]
  ds_read_b128 v[104:107], v141 offset:0
  ds_read_b128 v[108:111], v141 offset:2048
  v_mfma_f32_16x16x32_bf16 v[40:43], v[80:83], v[76:79], v[40:43]
  ds_read_b64_tr_b16 v[112:113], v142 offset:6144
  ds_read_b64_tr_b16 v[114:115], v142 offset:6912
  v_mfma_f32_16x16x32_bf16 v[64:67], v[80:83], v[136:139], v[64:67]
  ds_read_b64_tr_b16 v[116:117], v143 offset:6144
  ds_read_b64_tr_b16 v[118:119], v143 offset:6912
  v_mfma_f32_16x16x32_bf16 v[20:23], v[84:87], v[72:75], v[20:23]
  ds_read_b64_tr_b16 v[120:121], v144 offset:6144
  ds_read_b64_tr_b16 v[122:123], v144 offset:6912
  v_mfma_f32_16x16x32_bf16 v[44:47], v[84:87], v[76:79], v[44:47]
  ds_read_b64_tr_b16 v[124:125], v145 offset:6144
  ds_read_b64_tr_b16 v[126:127], v145 offset:6912
  v_mfma_f32_16x16x32_bf16 v[68:71], v[84:87], v[136:139], v[68:71]
  ds_read_b64_tr_b16 v[128:129], v146 offset:6144
  ds_read_b64_tr_b16 v[130:131], v146 offset:6912
  v_mfma_f32_16x16x32_bf16 v[24:27], v[88:91], v[72:75], v[24:27]
  ds_read_b64_tr_b16 v[132:133], v147 offset:6144
  ds_read_b64_tr_b16 v[134:135], v147 offset:6912
  v_mfma_f32_16x16x32_bf16 v[48:51], v[88:91], v[76:79], v[48:51]
  v_mfma_f32_16x16x32_bf16 v[28:31], v[92:95], v[72:75], v[28:31]
  v_mfma_f32_16x16x32_bf16 v[52:55], v[92:95], v[76:79], v[52:55]
  v_mfma_f32_16x16x32_bf16 v[32:35], v[96:99], v[72:75], v[32:35]
  v_mfma_f32_16x16x32_bf16 v[56:59], v[96:99], v[76:79], v[56:59]
  v_mfma_f32_16x16x32_bf16 v[36:39], v[100:103], v[72:75], v[36:39]
  v_mfma_f32_16x16x32_bf16 v[60:63], v[100:103], v[76:79], v[60:63]
  s_waitcnt lgkmcnt(0)
  s_barrier
  v_mfma_f32_16x16x32_bf16 v[16:19], v[112:115], v[104:107], v[16:19]
  ds_read_b128 v[72:75], v140 offset:16384
  ds_read_b128 v[76:79], v140 offset:18432
  v_mfma_f32_16x16x32_bf16 v[40:43], v[112:115], v[108:111], v[40:43]
  ds_read_b64_tr_b16 v[80:81], v142 offset:12288
  ds_read_b64_tr_b16 v[82:83], v142 offset:13056
  v_mfma_f32_16x16x32_bf16 v[64:67], v[112:115], v[136:139], v[64:67]
  ds_read_b64_tr_b16 v[84:85], v143 offset:12288
  ds_read_b64_tr_b16 v[86:87], v143 offset:13056
  v_mfma_f32_16x16x32_bf16 v[20:23], v[116:119], v[104:107], v[20:23]
  ds_read_b64_tr_b16 v[88:89], v144 offset:12288
  ds_read_b64_tr_b16 v[90:91], v144 offset:13056
  v_mfma_f32_16x16x32_bf16 v[44:47], v[116:119], v[108:111], v[44:47]
  ds_read_b64_tr_b16 v[92:93], v145 offset:12288
  ds_read_b64_tr_b16 v[94:95], v145 offset:13056
  v_mfma_f32_16x16x32_bf16 v[68:71], v[116:119], v[136:139], v[68:71]
  ds_read_b64_tr_b16 v[96:97], v146 offset:12288
  ds_read_b64_tr_b16 v[98:99], v146 offset:13056
  v_mfma_f32_16x16x32_bf16 v[24:27], v[120:123], v[104:107], v[24:27]
  ds_read_b64_tr_b16 v[100:101], v147 offset:12288
  ds_read_b64_tr_b16 v[102:103], v147 offset:13056
  v_mfma_f32_16x16x32_bf16 v[48:51], v[120:123], v[108:111], v[48:51]
  v_mfma_f32_16x16x32_bf16 v[28:31], v[124:127], v[104:107], v[28:31]
  v_mfma_f32_16x16x32_bf16 v[52:55], v[124:127], v[108:111], v[52:55]
  v_mfma_f32_16x16x32_bf16 v[32:35], v[128:131], v[104:107], v[32:35]
  v_mfma_f32_16x16x32_bf16 v[56:59], v[128:131], v[108:111], v[56:59]
  v_mfma_f32_16x16x32_bf16 v[36:39], v[132:135], v[104:107], v[36:39]
  v_mfma_f32_16x16x32_bf16 v[60:63], v[132:135], v[108:111], v[60:63]
  s_waitcnt lgkmcnt(0)
  v_mfma_f32_16x16x32_bf16 v[16:19], v[80:83], v[72:75], v[16:19]
  ds_read_b128 v[104:107], v141 offset:16384
  ds_read_b128 v[108:111], v141 offset:18432
  v_mfma_f32_16x16x32_bf16 v[40:43], v[80:83], v[76:79], v[40:43]
  ds_read_b64_tr_b16 v[112:113], v142 offset:18432
  ds_read_b64_tr_b16 v[114:115], v142 offset:19200
  v_mfma_f32_16x16x32_bf16 v[64:67], v[80:83], v[136:139], v[64:67]
  ds_read_b64_tr_b16 v[116:117], v143 offset:18432
  ds_read_b64_tr_b16 v[118:119], v143 offset:19200
  v_mfma_f32_16x16x32_bf16 v[20:23], v[84:87], v[72:75], v[20:23]
  ds_read_b64_tr_b16 v[120:121], v144 offset:18432
  ds_read_b64_tr_b16 v[122:123], v144 offset:19200
  v_mfma_f32_16x16x32_bf16 v[44:47], v[84:87], v[76:79], v[44:47]
  ds_read_b64_tr_b16 v[124:125], v145 offset:18432
  ds_read_b64_tr_b16 v[126:127], v145 offset:19200
  v_mfma_f32_16x16x32_bf16 v[68:71], v[84:87], v[136:139], v[68:71]
  ds_read_b64_tr_b16 v[128:129], v146 offset:18432
  ds_read_b64_tr_b16 v[130:131], v146 offset:19200
  v_mfma_f32_16x16x32_bf16 v[24:27], v[88:91], v[72:75], v[24:27]
  ds_read_b64_tr_b16 v[132:133], v147 offset:18432
  ds_read_b64_tr_b16 v[134:135], v147 offset:19200
  v_mfma_f32_16x16x32_bf16 v[48:51], v[88:91], v[76:79], v[48:51]
  v_mfma_f32_16x16x32_bf16 v[28:31], v[92:95], v[72:75], v[28:31]
  v_mfma_f32_16x16x32_bf16 v[52:55], v[92:95], v[76:79], v[52:55]
  v_mfma_f32_16x16x32_bf16 v[32:35], v[96:99], v[72:75], v[32:35]
  v_mfma_f32_16x16x32_bf16 v[56:59], v[96:99], v[76:79], v[56:59]
  v_mfma_f32_16x16x32_bf16 v[36:39], v[100:103], v[72:75], v[36:39]
  v_mfma_f32_16x16x32_bf16 v[60:63], v[100:103], v[76:79], v[60:63]
  s_waitcnt lgkmcnt(0)
  v_mfma_f32_16x16x32_bf16 v[16:19], v[112:115], v[104:107], v[16:19]
  v_mfma_f32_16x16x32_bf16 v[40:43], v[112:115], v[108:111], v[40:43]
  v_mfma_f32_16x16x32_bf16 v[64:67], v[112:115], v[136:139], v[64:67]
  v_mfma_f32_16x16x32_bf16 v[20:23], v[116:119], v[104:107], v[20:23]
  v_mfma_f32_16x16x32_bf16 v[44:47], v[116:119], v[108:111], v[44:47]
  v_mfma_f32_16x16x32_bf16 v[68:71], v[116:119], v[136:139], v[68:71]
  v_mfma_f32_16x16x32_bf16 v[24:27], v[120:123], v[104:107], v[24:27]
  v_mfma_f32_16x16x32_bf16 v[48:51], v[120:123], v[108:111], v[48:51]
  v_mfma_f32_16x16x32_bf16 v[28:31], v[124:127], v[104:107], v[28:31]
  v_mfma_f32_16x16x32_bf16 v[52:55], v[124:127], v[108:111], v[52:55]
  v_mfma_f32_16x16x32_bf16 v[32:35], v[128:131], v[104:107], v[32:35]
  v_mfma_f32_16x16x32_bf16 v[56:59], v[128:131], v[108:111], v[56:59]
  v_mfma_f32_16x16x32_bf16 v[36:39], v[132:135], v[104:107], v[36:39]
  v_mfma_f32_16x16x32_bf16 v[60:63], v[132:135], v[108:111], v[60:63]
  v_lshlrev_b32 v6, 4, v3
  s_lshl_b32 s40, s8, 7
  s_add_u32 s40, s40, 148480
  v_add_u32 v7, s40, v6
  s_lshl_b32 s40, s4, 8
  s_add_u32 s40, s40, 147456
  v_lshlrev_b32 v8, 2, v2
  v_add_u32 v8, s40, v8
  s_lshl_b32 s40, s44, 7
  s_add_u32 s40, s40, 148480
  v_add_u32 v9, s40, v6
  s_lshl_b32 s40, s45, 7
  s_add_u32 s40, s40, 148480
  v_add_u32 v10, s40, v6
  s_lshl_b32 s40, s46, 7
  s_add_u32 s40, s40, 148480
  v_add_u32 v11, s40, v6
  v_lshlrev_b32 v12, 4, v1
  s_mov_b32 exec_lo, 0x00010001
  s_mov_b32 exec_hi, 0x00010001
  s_nop 4
  ds_write_b128 v7, v[64:67]
  ds_write_b128 v7, v[68:71] offset:64
  s_mov_b64 exec, -1
  s_mov_b32 s24, s38
  s_mov_b32 s25, s39
  s_mov_b32 s26, 0xa60000
  s_mov_b32 s27, 0x00020000
  s_waitcnt lgkmcnt(0)
  s_barrier
  ds_read_b32 v72, v8 offset:0
  ds_read_b32 v76, v8 offset:128
  ds_read_b32 v74, v8 offset:64
  ds_read_b32 v78, v8 offset:192
  ds_read_b128 v[80:83], v9 offset:0
  ds_read_b128 v[84:87], v9 offset:64
  ds_read_b128 v[88:91], v10 offset:0
  ds_read_b128 v[92:95], v10 offset:64
  ds_read_b128 v[96:99], v11 offset:0
  ds_read_b128 v[100:103], v11 offset:64
  s_mov_b32 s40, 0x3acccccd
  s_mov_b32 s41, 0x3727c5ac
  s_mov_b32 s42, 0xbfb8aa3b
  v_mov_b32 v104, 1.0
  v_mov_b32 v105, 1.0
  s_waitcnt lgkmcnt(6)
  v_mul_f32 v72, s40, v72
  v_mul_f32 v76, s40, v76
  v_fma_f32 v76, -v72, v72, v76
  v_add_f32 v76, s41, v76
  v_rsq_f32 v76, v76
  v_mul_f32 v74, s40, v74
  v_mul_f32 v78, s40, v78
  v_fma_f32 v78, -v74, v74, v78
  v_add_f32 v78, s41, v78
  v_rsq_f32 v78, v78
  s_nop 0
  v_mul_f32 v106, s42, v76
  v_mul_f32 v108, s42, v78
  s_waitcnt lgkmcnt(0)
  s_mul_i32 s40, s7, 96
  s_mul_i32 s41, s6, 3
  s_add_u32 s40, s40, s41
  v_pk_fma_f32 v[112:113], v[80:81], v[72:73], v[16:17] op_sel_hi:[1,0,1] neg_lo:[0,1,0] neg_hi:[0,1,0]
  v_pk_fma_f32 v[114:115], v[82:83], v[72:73], v[18:19] op_sel_hi:[1,0,1] neg_lo:[0,1,0] neg_hi:[0,1,0]
  v_pk_fma_f32 v[116:117], v[84:85], v[72:73], v[20:21] op_sel_hi:[1,0,1] neg_lo:[0,1,0] neg_hi:[0,1,0]
  v_pk_fma_f32 v[118:119], v[86:87], v[72:73], v[22:23] op_sel_hi:[1,0,1] neg_lo:[0,1,0] neg_hi:[0,1,0]
  v_pk_mul_f32 v[120:121], v[112:113], v[106:107] op_sel_hi:[1,0]
  v_pk_mul_f32 v[122:123], v[114:115], v[106:107] op_sel_hi:[1,0]
  v_pk_mul_f32 v[124:125], v[116:117], v[106:107] op_sel_hi:[1,0]
  v_pk_mul_f32 v[126:127], v[118:119], v[106:107] op_sel_hi:[1,0]
  v_exp_f32 v120, v120
  v_exp_f32 v121, v121
  v_exp_f32 v122, v122
  v_exp_f32 v123, v123
  v_exp_f32 v124, v124
  v_exp_f32 v125, v125
  v_exp_f32 v126, v126
  v_exp_f32 v127, v127
  v_pk_mul_f32 v[112:113], v[112:113], v[76:77] op_sel_hi:[1,0]
  v_pk_mul_f32 v[114:115], v[114:115], v[76:77] op_sel_hi:[1,0]
  v_pk_mul_f32 v[116:117], v[116:117], v[76:77] op_sel_hi:[1,0]
  v_pk_mul_f32 v[118:119], v[118:119], v[76:77] op_sel_hi:[1,0]
  v_pk_add_f32 v[120:121], v[120:121], v[104:105]
  v_pk_add_f32 v[122:123], v[122:123], v[104:105]
  v_pk_add_f32 v[124:125], v[124:125], v[104:105]
  v_pk_add_f32 v[126:127], v[126:127], v[104:105]
  v_rcp_f32 v120, v120
  v_rcp_f32 v121, v121
  v_rcp_f32 v122, v122
  v_rcp_f32 v123, v123
  v_rcp_f32 v124, v124
  v_rcp_f32 v125, v125
  v_rcp_f32 v126, v126
  v_rcp_f32 v127, v127
  s_add_u32 s41, s40, s44
  s_add_u32 s41, s41, 0
  s_lshl_b32 s41, s41, 10
  v_pk_mul_f32 v[112:113], v[112:113], v[120:121]
  v_pk_mul_f32 v[114:115], v[114:115], v[122:123]
  v_pk_mul_f32 v[116:117], v[116:117], v[124:125]
  v_pk_mul_f32 v[118:119], v[118:119], v[126:127]
  v_cvt_pk_bf16_f32 v128, v112, v113
  v_cvt_pk_bf16_f32 v129, v114, v115
  v_cvt_pk_bf16_f32 v130, v116, v117
  v_cvt_pk_bf16_f32 v131, v118, v119
  buffer_store_dwordx4 v[128:131], v12, s[24:27], s41 offen
  v_pk_fma_f32 v[112:113], v[88:89], v[72:73], v[24:25] op_sel_hi:[1,0,1] neg_lo:[0,1,0] neg_hi:[0,1,0]
  v_pk_fma_f32 v[114:115], v[90:91], v[72:73], v[26:27] op_sel_hi:[1,0,1] neg_lo:[0,1,0] neg_hi:[0,1,0]
  v_pk_fma_f32 v[116:117], v[92:93], v[72:73], v[28:29] op_sel_hi:[1,0,1] neg_lo:[0,1,0] neg_hi:[0,1,0]
  v_pk_fma_f32 v[118:119], v[94:95], v[72:73], v[30:31] op_sel_hi:[1,0,1] neg_lo:[0,1,0] neg_hi:[0,1,0]
  v_pk_mul_f32 v[120:121], v[112:113], v[106:107] op_sel_hi:[1,0]
  v_pk_mul_f32 v[122:123], v[114:115], v[106:107] op_sel_hi:[1,0]
  v_pk_mul_f32 v[124:125], v[116:117], v[106:107] op_sel_hi:[1,0]
  v_pk_mul_f32 v[126:127], v[118:119], v[106:107] op_sel_hi:[1,0]
  v_exp_f32 v120, v120
  v_exp_f32 v121, v121
  v_exp_f32 v122, v122
  v_exp_f32 v123, v123
  v_exp_f32 v124, v124
  v_exp_f32 v125, v125
  v_exp_f32 v126, v126
  v_exp_f32 v127, v127
  v_pk_mul_f32 v[112:113], v[112:113], v[76:77] op_sel_hi:[1,0]
  v_pk_mul_f32 v[114:115], v[114:115], v[76:77] op_sel_hi:[1,0]
  v_pk_mul_f32 v[116:117], v[116:117], v[76:77] op_sel_hi:[1,0]
  v_pk_mul_f32 v[118:119], v[118:119], v[76:77] op_sel_hi:[1,0]
  v_pk_add_f32 v[120:121], v[120:121], v[104:105]
  v_pk_add_f32 v[122:123], v[122:123], v[104:105]
  v_pk_add_f32 v[124:125], v[124:125], v[104:105]
  v_pk_add_f32 v[126:127], v[126:127], v[104:105]
  v_rcp_f32 v120, v120
  v_rcp_f32 v121, v121
  v_rcp_f32 v122, v122
  v_rcp_f32 v123, v123
  v_rcp_f32 v124, v124
  v_rcp_f32 v125, v125
  v_rcp_f32 v126, v126
  v_rcp_f32 v127, v127
  s_add_u32 s41, s40, s45
  s_add_u32 s41, s41, 0
  s_lshl_b32 s41, s41, 10
  v_pk_mul_f32 v[112:113], v[112:113], v[120:121]
  v_pk_mul_f32 v[114:115], v[114:115], v[122:123]
  v_pk_mul_f32 v[116:117], v[116:117], v[124:125]
  v_pk_mul_f32 v[118:119], v[118:119], v[126:127]
  v_cvt_pk_bf16_f32 v132, v112, v113
  v_cvt_pk_bf16_f32 v133, v114, v115
  v_cvt_pk_bf16_f32 v134, v116, v117
  v_cvt_pk_bf16_f32 v135, v118, v119
  buffer_store_dwordx4 v[132:135], v12, s[24:27], s41 offen
  v_pk_fma_f32 v[112:113], v[96:97], v[72:73], v[32:33] op_sel_hi:[1,0,1] neg_lo:[0,1,0] neg_hi:[0,1,0]
  v_pk_fma_f32 v[114:115], v[98:99], v[72:73], v[34:35] op_sel_hi:[1,0,1] neg_lo:[0,1,0] neg_hi:[0,1,0]
  v_pk_fma_f32 v[116:117], v[100:101], v[72:73], v[36:37] op_sel_hi:[1,0,1] neg_lo:[0,1,0] neg_hi:[0,1,0]
  v_pk_fma_f32 v[118:119], v[102:103], v[72:73], v[38:39] op_sel_hi:[1,0,1] neg_lo:[0,1,0] neg_hi:[0,1,0]
  v_pk_mul_f32 v[120:121], v[112:113], v[106:107] op_sel_hi:[1,0]
  v_pk_mul_f32 v[122:123], v[114:115], v[106:107] op_sel_hi:[1,0]
  v_pk_mul_f32 v[124:125], v[116:117], v[106:107] op_sel_hi:[1,0]
  v_pk_mul_f32 v[126:127], v[118:119], v[106:107] op_sel_hi:[1,0]
  v_exp_f32 v120, v120
  v_exp_f32 v121, v121
  v_exp_f32 v122, v122
  v_exp_f32 v123, v123
  v_exp_f32 v124, v124
  v_exp_f32 v125, v125
  v_exp_f32 v126, v126
  v_exp_f32 v127, v127
  v_pk_mul_f32 v[112:113], v[112:113], v[76:77] op_sel_hi:[1,0]
  v_pk_mul_f32 v[114:115], v[114:115], v[76:77] op_sel_hi:[1,0]
  v_pk_mul_f32 v[116:117], v[116:117], v[76:77] op_sel_hi:[1,0]
  v_pk_mul_f32 v[118:119], v[118:119], v[76:77] op_sel_hi:[1,0]
  v_pk_add_f32 v[120:121], v[120:121], v[104:105]
  v_pk_add_f32 v[122:123], v[122:123], v[104:105]
  v_pk_add_f32 v[124:125], v[124:125], v[104:105]
  v_pk_add_f32 v[126:127], v[126:127], v[104:105]
  v_rcp_f32 v120, v120
  v_rcp_f32 v121, v121
  v_rcp_f32 v122, v122
  v_rcp_f32 v123, v123
  v_rcp_f32 v124, v124
  v_rcp_f32 v125, v125
  v_rcp_f32 v126, v126
  v_rcp_f32 v127, v127
  s_add_u32 s41, s40, s46
  s_add_u32 s41, s41, 0
  s_lshl_b32 s41, s41, 10
  v_pk_mul_f32 v[112:113], v[112:113], v[120:121]
  v_pk_mul_f32 v[114:115], v[114:115], v[122:123]
  v_pk_mul_f32 v[116:117], v[116:117], v[124:125]
  v_pk_mul_f32 v[118:119], v[118:119], v[126:127]
  v_cvt_pk_bf16_f32 v136, v112, v113
  v_cvt_pk_bf16_f32 v137, v114, v115
  v_cvt_pk_bf16_f32 v138, v116, v117
  v_cvt_pk_bf16_f32 v139, v118, v119
  buffer_store_dwordx4 v[136:139], v12, s[24:27], s41 offen
  v_pk_fma_f32 v[112:113], v[80:81], v[74:75], v[40:41] op_sel_hi:[1,0,1] neg_lo:[0,1,0] neg_hi:[0,1,0]
  v_pk_fma_f32 v[114:115], v[82:83], v[74:75], v[42:43] op_sel_hi:[1,0,1] neg_lo:[0,1,0] neg_hi:[0,1,0]
  v_pk_fma_f32 v[116:117], v[84:85], v[74:75], v[44:45] op_sel_hi:[1,0,1] neg_lo:[0,1,0] neg_hi:[0,1,0]
  v_pk_fma_f32 v[118:119], v[86:87], v[74:75], v[46:47] op_sel_hi:[1,0,1] neg_lo:[0,1,0] neg_hi:[0,1,0]
  v_pk_mul_f32 v[120:121], v[112:113], v[108:109] op_sel_hi:[1,0]
  v_pk_mul_f32 v[122:123], v[114:115], v[108:109] op_sel_hi:[1,0]
  v_pk_mul_f32 v[124:125], v[116:117], v[108:109] op_sel_hi:[1,0]
  v_pk_mul_f32 v[126:127], v[118:119], v[108:109] op_sel_hi:[1,0]
  v_exp_f32 v120, v120
  v_exp_f32 v121, v121
  v_exp_f32 v122, v122
  v_exp_f32 v123, v123
  v_exp_f32 v124, v124
  v_exp_f32 v125, v125
  v_exp_f32 v126, v126
  v_exp_f32 v127, v127
  v_pk_mul_f32 v[112:113], v[112:113], v[78:79] op_sel_hi:[1,0]
  v_pk_mul_f32 v[114:115], v[114:115], v[78:79] op_sel_hi:[1,0]
  v_pk_mul_f32 v[116:117], v[116:117], v[78:79] op_sel_hi:[1,0]
  v_pk_mul_f32 v[118:119], v[118:119], v[78:79] op_sel_hi:[1,0]
  v_pk_add_f32 v[120:121], v[120:121], v[104:105]
  v_pk_add_f32 v[122:123], v[122:123], v[104:105]
  v_pk_add_f32 v[124:125], v[124:125], v[104:105]
  v_pk_add_f32 v[126:127], v[126:127], v[104:105]
  v_rcp_f32 v120, v120
  v_rcp_f32 v121, v121
  v_rcp_f32 v122, v122
  v_rcp_f32 v123, v123
  v_rcp_f32 v124, v124
  v_rcp_f32 v125, v125
  v_rcp_f32 v126, v126
  v_rcp_f32 v127, v127
  s_add_u32 s41, s40, s44
  s_add_u32 s41, s41, 48
  s_lshl_b32 s41, s41, 10
  v_pk_mul_f32 v[112:113], v[112:113], v[120:121]
  v_pk_mul_f32 v[114:115], v[114:115], v[122:123]
  v_pk_mul_f32 v[116:117], v[116:117], v[124:125]
  v_pk_mul_f32 v[118:119], v[118:119], v[126:127]
  v_cvt_pk_bf16_f32 v140, v112, v113
  v_cvt_pk_bf16_f32 v141, v114, v115
  v_cvt_pk_bf16_f32 v142, v116, v117
  v_cvt_pk_bf16_f32 v143, v118, v119
  buffer_store_dwordx4 v[140:143], v12, s[24:27], s41 offen
  s_barrier
  v_pk_fma_f32 v[112:113], v[88:89], v[74:75], v[48:49] op_sel_hi:[1,0,1] neg_lo:[0,1,0] neg_hi:[0,1,0]
  v_pk_fma_f32 v[114:115], v[90:91], v[74:75], v[50:51] op_sel_hi:[1,0,1] neg_lo:[0,1,0] neg_hi:[0,1,0]
  v_pk_fma_f32 v[116:117], v[92:93], v[74:75], v[52:53] op_sel_hi:[1,0,1] neg_lo:[0,1,0] neg_hi:[0,1,0]
  v_pk_fma_f32 v[118:119], v[94:95], v[74:75], v[54:55] op_sel_hi:[1,0,1] neg_lo:[0,1,0] neg_hi:[0,1,0]
  v_pk_mul_f32 v[120:121], v[112:113], v[108:109] op_sel_hi:[1,0]
  v_pk_mul_f32 v[122:123], v[114:115], v[108:109] op_sel_hi:[1,0]
  v_pk_mul_f32 v[124:125], v[116:117], v[108:109] op_sel_hi:[1,0]
  v_pk_mul_f32 v[126:127], v[118:119], v[108:109] op_sel_hi:[1,0]
  v_exp_f32 v120, v120
  v_exp_f32 v121, v121
  v_exp_f32 v122, v122
  v_exp_f32 v123, v123
  v_exp_f32 v124, v124
  v_exp_f32 v125, v125
  v_exp_f32 v126, v126
  v_exp_f32 v127, v127
  v_pk_mul_f32 v[112:113], v[112:113], v[78:79] op_sel_hi:[1,0]
  v_pk_mul_f32 v[114:115], v[114:115], v[78:79] op_sel_hi:[1,0]
  v_pk_mul_f32 v[116:117], v[116:117], v[78:79] op_sel_hi:[1,0]
  v_pk_mul_f32 v[118:119], v[118:119], v[78:79] op_sel_hi:[1,0]
  v_pk_add_f32 v[120:121], v[120:121], v[104:105]
  v_pk_add_f32 v[122:123], v[122:123], v[104:105]
  v_pk_add_f32 v[124:125], v[124:125], v[104:105]
  v_pk_add_f32 v[126:127], v[126:127], v[104:105]
  v_rcp_f32 v120, v120
  v_rcp_f32 v121, v121
  v_rcp_f32 v122, v122
  v_rcp_f32 v123, v123
  v_rcp_f32 v124, v124
  v_rcp_f32 v125, v125
  v_rcp_f32 v126, v126
  v_rcp_f32 v127, v127
  s_add_u32 s41, s40, s45
  s_add_u32 s41, s41, 48
  s_lshl_b32 s41, s41, 10
  v_pk_mul_f32 v[112:113], v[112:113], v[120:121]
  v_pk_mul_f32 v[114:115], v[114:115], v[122:123]
  v_pk_mul_f32 v[116:117], v[116:117], v[124:125]
  v_pk_mul_f32 v[118:119], v[118:119], v[126:127]
  v_cvt_pk_bf16_f32 v144, v112, v113
  v_cvt_pk_bf16_f32 v145, v114, v115
  v_cvt_pk_bf16_f32 v146, v116, v117
  v_cvt_pk_bf16_f32 v147, v118, v119
  buffer_store_dwordx4 v[144:147], v12, s[24:27], s41 offen
  v_pk_fma_f32 v[112:113], v[96:97], v[74:75], v[56:57] op_sel_hi:[1,0,1] neg_lo:[0,1,0] neg_hi:[0,1,0]
  v_pk_fma_f32 v[114:115], v[98:99], v[74:75], v[58:59] op_sel_hi:[1,0,1] neg_lo:[0,1,0] neg_hi:[0,1,0]
  v_pk_fma_f32 v[116:117], v[100:101], v[74:75], v[60:61] op_sel_hi:[1,0,1] neg_lo:[0,1,0] neg_hi:[0,1,0]
  v_pk_fma_f32 v[118:119], v[102:103], v[74:75], v[62:63] op_sel_hi:[1,0,1] neg_lo:[0,1,0] neg_hi:[0,1,0]
  v_pk_mul_f32 v[120:121], v[112:113], v[108:109] op_sel_hi:[1,0]
  v_pk_mul_f32 v[122:123], v[114:115], v[108:109] op_sel_hi:[1,0]
  v_pk_mul_f32 v[124:125], v[116:117], v[108:109] op_sel_hi:[1,0]
  v_pk_mul_f32 v[126:127], v[118:119], v[108:109] op_sel_hi:[1,0]
  v_exp_f32 v120, v120
  v_exp_f32 v121, v121
  v_exp_f32 v122, v122
  v_exp_f32 v123, v123
  v_exp_f32 v124, v124
  v_exp_f32 v125, v125
  v_exp_f32 v126, v126
  v_exp_f32 v127, v127
  v_pk_mul_f32 v[112:113], v[112:113], v[78:79] op_sel_hi:[1,0]
  v_pk_mul_f32 v[114:115], v[114:115], v[78:79] op_sel_hi:[1,0]
  v_pk_mul_f32 v[116:117], v[116:117], v[78:79] op_sel_hi:[1,0]
  v_pk_mul_f32 v[118:119], v[118:119], v[78:79] op_sel_hi:[1,0]
  v_pk_add_f32 v[120:121], v[120:121], v[104:105]
  v_pk_add_f32 v[122:123], v[122:123], v[104:105]
  v_pk_add_f32 v[124:125], v[124:125], v[104:105]
  v_pk_add_f32 v[126:127], v[126:127], v[104:105]
  v_rcp_f32 v120, v120
  v_rcp_f32 v121, v121
  v_rcp_f32 v122, v122
  v_rcp_f32 v123, v123
  v_rcp_f32 v124, v124
  v_rcp_f32 v125, v125
  v_rcp_f32 v126, v126
  v_rcp_f32 v127, v127
  s_add_u32 s41, s40, s46
  s_add_u32 s41, s41, 48
  s_lshl_b32 s41, s41, 10
  v_pk_mul_f32 v[112:113], v[112:113], v[120:121]
  v_pk_mul_f32 v[114:115], v[114:115], v[122:123]
  v_pk_mul_f32 v[116:117], v[116:117], v[124:125]
  v_pk_mul_f32 v[118:119], v[118:119], v[126:127]
  v_cvt_pk_bf16_f32 v148, v112, v113
  v_cvt_pk_bf16_f32 v149, v114, v115
  v_cvt_pk_bf16_f32 v150, v116, v117
  v_cvt_pk_bf16_f32 v151, v118, v119
  buffer_store_dwordx4 v[148:151], v12, s[24:27], s41 offen
  s_endpgm
L1_B:
  s_cmp_ge_u32 s3, 8
  s_cbranch_scc1 L1_L
  s_lshl_b32 s50, s4, 12
  v_add_u32 v121, s50, v4
  v_add_u32 v122, s50, v5
  v_add_u32 v123, 114688, v4
  v_add_u32 v124, 114688, v5
  v_mul_u32_u24 v6, 1280, v3
  v_lshl_add_u32 v6, v2, 4, v6
  s_lshl_b32 s40, s4, 2
  v_add_u32 v125, s40, v6
  s_lshl_b32 s40, s4, 6
  s_mov_b32 s41, 81920
  s_add_u32 s42, s40, 0
  v_add_u32 v6, s42, v1
  v_lshlrev_b32 v112, 4, v6
  v_mul_u32_u24 v7, 3277, v6
  v_lshrrev_b32 v7, 16, v7
  v_mul_u32_u24 v8, 20, v7
  v_sub_u32 v8, v6, v8
  v_mul_lo_u32 v7, v7, s41
  v_lshl_add_u32 v115, v8, 4, v7
  s_add_u32 s42, s40, 256
  v_add_u32 v6, s42, v1
  v_lshlrev_b32 v113, 4, v6
  v_mul_u32_u24 v7, 3277, v6
  v_lshrrev_b32 v7, 16, v7
  v_mul_u32_u24 v8, 20, v7
  v_sub_u32 v8, v6, v8
  v_mul_lo_u32 v7, v7, s41
  v_lshl_add_u32 v116, v8, 4, v7
  s_add_u32 s42, s40, 512
  v_add_u32 v6, s42, v1
  v_lshlrev_b32 v114, 4, v6
  v_mul_u32_u24 v7, 3277, v6
  v_lshrrev_b32 v7, 16, v7
  v_mul_u32_u24 v8, 20, v7
  v_sub_u32 v8, v6, v8
  v_mul_lo_u32 v7, v7, s41
  v_lshl_add_u32 v117, v8, 4, v7
  v_lshlrev_b32 v6, 8, v3
  v_add_u32 v6, s7, v6
  v_cvt_f32_u32 v6, v6
  v_mul_f32 v6, 0x3a000000, v6
  v_cvt_f32_u32 v7, v2
  v_add_f32 v8, 0x41800000, v7
  v_add_f32 v9, 0x0, v6
  v_mul_f32 v9, v9, v7
  v_cos_f32 v128, v9
  v_sin_f32 v136, v9
  v_add_f32 v9, 0x3d000000, v6
  v_mul_f32 v9, v9, v7
  v_cos_f32 v129, v9
  v_sin_f32 v137, v9
  v_add_f32 v9, 0x3d800000, v6
  v_mul_f32 v9, v9, v7
  v_cos_f32 v130, v9
  v_sin_f32 v138, v9
  v_add_f32 v9, 0x3dc00000, v6
  v_mul_f32 v9, v9, v7
  v_cos_f32 v131, v9
  v_sin_f32 v139, v9
  v_add_f32 v9, 0x3f000000, v6
  v_mul_f32 v9, v9, v7
  v_cos_f32 v132, v9
  v_sin_f32 v140, v9
  v_add_f32 v9, 0x3f080000, v6
  v_mul_f32 v9, v9, v7
  v_cos_f32 v133, v9
  v_sin_f32 v141, v9
  v_add_f32 v9, 0x3f100000, v6
  v_mul_f32 v9, v9, v7
  v_cos_f32 v134, v9
  v_sin_f32 v142, v9
  v_add_f32 v9, 0x3f180000, v6
  v_mul_f32 v9, v9, v7
  v_cos_f32 v135, v9
  v_sin_f32 v143, v9
  s_nop 0
  v_cvt_pk_bf16_f32 v88, v128, v129
  v_cvt_pk_bf16_f32 v96, v136, v137
  v_cvt_pk_bf16_f32 v89, v130, v131
  v_cvt_pk_bf16_f32 v97, v138, v139
  v_cvt_pk_bf16_f32 v90, v132, v133
  v_cvt_pk_bf16_f32 v98, v140, v141
  v_cvt_pk_bf16_f32 v91, v134, v135
  v_cvt_pk_bf16_f32 v99, v142, v143
  v_xor_b32 v104, 0x80008000, v88
  v_xor_b32 v105, 0x80008000, v89
  v_xor_b32 v106, 0x80008000, v90
  v_xor_b32 v107, 0x80008000, v91
  v_add_f32 v9, 0x0, v6
  v_mul_f32 v9, v9, v8
  v_cos_f32 v128, v9
  v_sin_f32 v136, v9
  v_add_f32 v9, 0x3d000000, v6
  v_mul_f32 v9, v9, v8
  v_cos_f32 v129, v9
  v_sin_f32 v137, v9
  v_add_f32 v9, 0x3d800000, v6
  v_mul_f32 v9, v9, v8
  v_cos_f32 v130, v9
  v_sin_f32 v138, v9
  v_add_f32 v9, 0x3dc00000, v6
  v_mul_f32 v9, v9, v8
  v_cos_f32 v131, v9
  v_sin_f32 v139, v9
  v_add_f32 v9, 0x3f000000, v6
  v_mul_f32 v9, v9, v8
  v_cos_f32 v132, v9
  v_sin_f32 v140, v9
  v_add_f32 v9, 0x3f080000, v6
  v_mul_f32 v9, v9, v8
  v_cos_f32 v133, v9
  v_sin_f32 v141, v9
  v_add_f32 v9, 0x3f100000, v6
  v_mul_f32 v9, v9, v8
  v_cos_f32 v134, v9
  v_sin_f32 v142, v9
  v_add_f32 v9, 0x3f180000, v6
  v_mul_f32 v9, v9, v8
  v_cos_f32 v135, v9
  v_sin_f32 v143, v9
  s_nop 0
  v_cvt_pk_bf16_f32 v92, v128, v129
  v_cvt_pk_bf16_f32 v100, v136, v137
  v_cvt_pk_bf16_f32 v93, v130, v131
  v_cvt_pk_bf16_f32 v101, v138, v139
  v_cvt_pk_bf16_f32 v94, v132, v133
  v_cvt_pk_bf16_f32 v102, v140, v141
  v_cvt_pk_bf16_f32 v95, v134, v135
  v_cvt_pk_bf16_f32 v103, v142, v143
  v_xor_b32 v108, 0x80008000, v92
  v_xor_b32 v109, 0x80008000, v93
  v_xor_b32 v110, 0x80008000, v94
  v_xor_b32 v111, 0x80008000, v95
  v_mov_b32 v16, 0
  v_mov_b32 v17, 0
  v_mov_b32 v18, 0
  v_mov_b32 v19, 0
  v_mov_b32 v20, 0
  v_mov_b32 v21, 0
  v_mov_b32 v22, 0
  v_mov_b32 v23, 0
  v_mov_b32 v24, 0
  v_mov_b32 v25, 0
  v_mov_b32 v26, 0
  v_mov_b32 v27, 0
  v_mov_b32 v28, 0
  v_mov_b32 v29, 0
  v_mov_b32 v30, 0
  v_mov_b32 v31, 0
  v_mov_b32 v32, 0
  v_mov_b32 v33, 0
  v_mov_b32 v34, 0
  v_mov_b32 v35, 0
  v_mov_b32 v36, 0
  v_mov_b32 v37, 0
  v_mov_b32 v38, 0
  v_mov_b32 v39, 0
  v_mov_b32 v40, 0
  v_mov_b32 v41, 0
  v_mov_b32 v42, 0
  v_mov_b32 v43, 0
  v_mov_b32 v44, 0
  v_mov_b32 v45, 0
  v_mov_b32 v46, 0
  v_mov_b32 v47, 0
  s_waitcnt lgkmcnt(0)
  s_mov_b32 s24, s38
  s_mov_b32 s25, s39
  s_mov_b32 s26, 0xa60000
  s_mov_b32 s27, 0x00020000
  s_barrier
  ds_read_b128 v[48:51], v121 offset:0
  ds_read_b128 v[52:55], v121 offset:2048
  ds_read_b128 v[56:59], v123 offset:0
  ds_read_b128 v[60:63], v123 offset:2048
  ds_read_b128 v[64:67], v123 offset:4096
  s_waitcnt lgkmcnt(0)
  v_mfma_f32_16x16x32_bf16 v[16:19], v[48:51], v[56:59], v[16:19]
  ds_read_b128 v[68:71], v122 offset:0
  ds_read_b128 v[72:75], v122 offset:2048
  v_mfma_f32_16x16x32_bf16 v[28:31], v[52:55], v[56:59], v[28:31]
  ds_read_b128 v[76:79], v124 offset:0
  ds_read_b128 v[80:83], v124 offset:2048
  v_mfma_f32_16x16x32_bf16 v[20:23], v[48:51], v[60:63], v[20:23]
  ds_read_b128 v[84:87], v124 offset:4096
  v_mfma_f32_16x16x32_bf16 v[32:35], v[52:55], v[60:63], v[32:35]
  v_mfma_f32_16x16x32_bf16 v[24:27], v[48:51], v[64:67], v[24:27]
  v_mfma_f32_16x16x32_bf16 v[36:39], v[52:55], v[64:67], v[36:39]
  v_mfma_f32_16x16x32_bf16 v[40:43], v[48:51], v[48:51], v[40:43]
  v_mfma_f32_16x16x32_bf16 v[44:47], v[52:55], v[52:55], v[44:47]
  s_waitcnt lgkmcnt(0)
  s_barrier
  v_mfma_f32_16x16x32_bf16 v[16:19], v[68:71], v[76:79], v[16:19]
  ds_read_b128 v[48:51], v121 offset:16384
  ds_read_b128 v[52:55], v121 offset:18432
  v_mfma_f32_16x16x32_bf16 v[28:31], v[72:75], v[76:79], v[28:31]
  ds_read_b128 v[56:59], v123 offset:6144
  ds_read_b128 v[60:63], v123 offset:8192
  v_mfma_f32_16x16x32_bf16 v[20:23], v[68:71], v[80:83], v[20:23]
  ds_read_b128 v[64:67], v123 offset:10240
  v_mfma_f32_16x16x32_bf16 v[32:35], v[72:75], v[80:83], v[32:35]
  v_mfma_f32_16x16x32_bf16 v[24:27], v[68:71], v[84:87], v[24:27]
  v_mfma_f32_16x16x32_bf16 v[36:39], v[72:75], v[84:87], v[36:39]
  v_mfma_f32_16x16x32_bf16 v[40:43], v[68:71], v[68:71], v[40:43]
  v_mfma_f32_16x16x32_bf16 v[44:47], v[72:75], v[72:75], v[44:47]
  s_waitcnt lgkmcnt(0)
  v_mfma_f32_16x16x32_bf16 v[16:19], v[48:51], v[56:59], v[16:19]
  ds_read_b128 v[68:71], v122 offset:16384
  ds_read_b128 v[72:75], v122 offset:18432
  v_mfma_f32_16x16x32_bf16 v[28:31], v[52:55], v[56:59], v[28:31]
  ds_read_b128 v[76:79], v124 offset:6144
  ds_read_b128 v[80:83], v124 offset:8192
  v_mfma_f32_16x16x32_bf16 v[20:23], v[48:51], v[60:63], v[20:23]
  ds_read_b128 v[84:87], v124 offset:10240
  v_mfma_f32_16x16x32_bf16 v[32:35], v[52:55], v[60:63], v[32:35]
  v_mfma_f32_16x16x32_bf16 v[24:27], v[48:51], v[64:67], v[24:27]
  v_mfma_f32_16x16x32_bf16 v[36:39], v[52:55], v[64:67], v[36:39]
  v_mfma_f32_16x16x32_bf16 v[40:43], v[48:51], v[48:51], v[40:43]
  v_mfma_f32_16x16x32_bf16 v[44:47], v[52:55], v[52:55], v[44:47]
  s_waitcnt lgkmcnt(0)
  s_barrier
  v_mfma_f32_16x16x32_bf16 v[16:19], v[68:71], v[76:79], v[16:19]
  ds_read_b128 v[48:51], v121 offset:32768
  ds_read_b128 v[52:55], v121 offset:34816
  v_mfma_f32_16x16x32_bf16 v[28:31], v[72:75], v[76:79], v[28:31]
  ds_read_b128 v[56:59], v123 offset:12288
  ds_read_b128 v[60:63], v123 offset:14336
  v_mfma_f32_16x16x32_bf16 v[20:23], v[68:71], v[80:83], v[20:23]
  ds_read_b128 v[64:67], v123 offset:16384
  v_mfma_f32_16x16x32_bf16 v[32:35], v[72:75], v[80:83], v[32:35]
  v_mfma_f32_16x16x32_bf16 v[24:27], v[68:71], v[84:87], v[24:27]
  v_mfma_f32_16x16x32_bf16 v[36:39], v[72:75], v[84:87], v[36:39]
  v_mfma_f32_16x16x32_bf16 v[40:43], v[68:71], v[68:71], v[40:43]
  v_mfma_f32_16x16x32_bf16 v[44:47], v[72:75], v[72:75], v[44:47]
  s_waitcnt lgkmcnt(0)
  v_mfma_f32_16x16x32_bf16 v[16:19], v[48:51], v[56:59], v[16:19]
  ds_read_b128 v[68:71], v122 offset:32768
  ds_read_b128 v[72:75], v122 offset:34816
  v_mfma_f32_16x16x32_bf16 v[28:31], v[52:55], v[56:59], v[28:31]
  ds_read_b128 v[76:79], v124 offset:12288
  ds_read_b128 v[80:83], v124 offset:14336
  v_mfma_f32_16x16x32_bf16 v[20:23], v[48:51], v[60:63], v[20:23]
  ds_read_b128 v[84:87], v124 offset:16384
  v_mfma_f32_16x16x32_bf16 v[32:35], v[52:55], v[60:63], v[32:35]
  v_mfma_f32_16x16x32_bf16 v[24:27], v[48:51], v[64:67], v[24:27]
  v_mfma_f32_16x16x32_bf16 v[36:39], v[52:55], v[64:67], v[36:39]
  v_mfma_f32_16x16x32_bf16 v[40:43], v[48:51], v[48:51], v[40:43]
  v_mfma_f32_16x16x32_bf16 v[44:47], v[52:55], v[52:55], v[44:47]
  s_waitcnt lgkmcnt(0)
  s_barrier
  v_mfma_f32_16x16x32_bf16 v[16:19], v[68:71], v[76:79], v[16:19]
  ds_read_b128 v[48:51], v121 offset:49152
  ds_read_b128 v[52:55], v121 offset:51200
  v_mfma_f32_16x16x32_bf16 v[28:31], v[72:75], v[76:79], v[28:31]
  ds_read_b128 v[56:59], v123 offset:18432
  ds_read_b128 v[60:63], v123 offset:20480
  v_mfma_f32_16x16x32_bf16 v[20:23], v[68:71], v[80:83], v[20:23]
  ds_read_b128 v[64:67], v123 offset:22528
  v_mfma_f32_16x16x32_bf16 v[32:35], v[72:75], v[80:83], v[32:35]
  v_mfma_f32_16x16x32_bf16 v[24:27], v[68:71], v[84:87], v[24:27]
  v_mfma_f32_16x16x32_bf16 v[36:39], v[72:75], v[84:87], v[36:39]
  v_mfma_f32_16x16x32_bf16 v[40:43], v[68:71], v[68:71], v[40:43]
  v_mfma_f32_16x16x32_bf16 v[44:47], v[72:75], v[72:75], v[44:47]
  s_waitcnt lgkmcnt(0)
  v_mfma_f32_16x16x32_bf16 v[16:19], v[48:51], v[56:59], v[16:19]
  ds_read_b128 v[68:71], v122 offset:49152
  ds_read_b128 v[72:75], v122 offset:51200
  v_mfma_f32_16x16x32_bf16 v[28:31], v[52:55], v[56:59], v[28:31]
  ds_read_b128 v[76:79], v124 offset:18432
  ds_read_b128 v[80:83], v124 offset:20480
  v_mfma_f32_16x16x32_bf16 v[20:23], v[48:51], v[60:63], v[20:23]
  ds_read_b128 v[84:87], v124 offset:22528
  v_mfma_f32_16x16x32_bf16 v[32:35], v[52:55], v[60:63], v[32:35]
  v_mfma_f32_16x16x32_bf16 v[24:27], v[48:51], v[64:67], v[24:27]
  v_mfma_f32_16x16x32_bf16 v[36:39], v[52:55], v[64:67], v[36:39]
  v_mfma_f32_16x16x32_bf16 v[40:43], v[48:51], v[48:51], v[40:43]
  v_mfma_f32_16x16x32_bf16 v[44:47], v[52:55], v[52:55], v[44:47]
  s_waitcnt lgkmcnt(0)
  s_barrier
  v_mfma_f32_16x16x32_bf16 v[16:19], v[68:71], v[76:79], v[16:19]
  ds_read_b128 v[48:51], v121 offset:0
  ds_read_b128 v[52:55], v121 offset:2048
  v_mfma_f32_16x16x32_bf16 v[28:31], v[72:75], v[76:79], v[28:31]
  ds_read_b128 v[56:59], v123 offset:0
  ds_read_b128 v[60:63], v123 offset:2048
  v_mfma_f32_16x16x32_bf16 v[20:23], v[68:71], v[80:83], v[20:23]
  ds_read_b128 v[64:67], v123 offset:4096
  v_mfma_f32_16x16x32_bf16 v[32:35], v[72:75], v[80:83], v[32:35]
  v_mfma_f32_16x16x32_bf16 v[24:27], v[68:71], v[84:87], v[24:27]
  v_mfma_f32_16x16x32_bf16 v[36:39], v[72:75], v[84:87], v[36:39]
  v_mfma_f32_16x16x32_bf16 v[40:43], v[68:71], v[68:71], v[40:43]
  v_mfma_f32_16x16x32_bf16 v[44:47], v[72:75], v[72:75], v[44:47]
  s_waitcnt lgkmcnt(0)
  v_mfma_f32_16x16x32_bf16 v[16:19], v[48:51], v[56:59], v[16:19]
  ds_read_b128 v[68:71], v122 offset:0
  ds_read_b128 v[72:75], v122 offset:2048
  v_mfma_f32_16x16x32_bf16 v[28:31], v[52:55], v[56:59], v[28:31]
  ds_read_b128 v[76:79], v124 offset:0
  ds_read_b128 v[80:83], v124 offset:2048
  v_mfma_f32_16x16x32_bf16 v[20:23], v[48:51], v[60:63], v[20:23]
  ds_read_b128 v[84:87], v124 offset:4096
  v_mfma_f32_16x16x32_bf16 v[32:35], v[52:55], v[60:63], v[32:35]
  v_mfma_f32_16x16x32_bf16 v[24:27], v[48:51], v[64:67], v[24:27]
  v_mfma_f32_16x16x32_bf16 v[36:39], v[52:55], v[64:67], v[36:39]
  v_mfma_f32_16x16x32_bf16 v[40:43], v[48:51], v[48:51], v[40:43]
  v_mfma_f32_16x16x32_bf16 v[44:47], v[52:55], v[52:55], v[44:47]
  s_waitcnt lgkmcnt(0)
  s_barrier
  v_mfma_f32_16x16x32_bf16 v[16:19], v[68:71], v[76:79], v[16:19]
  ds_read_b128 v[48:51], v121 offset:16384
  ds_read_b128 v[52:55], v121 offset:18432
  v_mfma_f32_16x16x32_bf16 v[28:31], v[72:75], v[76:79], v[28:31]
  ds_read_b128 v[56:59], v123 offset:6144
  ds_read_b128 v[60:63], v123 offset:8192
  v_mfma_f32_16x16x32_bf16 v[20:23], v[68:71], v[80:83], v[20:23]
  ds_read_b128 v[64:67], v123 offset:10240
  v_mfma_f32_16x16x32_bf16 v[32:35], v[72:75], v[80:83], v[32:35]
  v_mfma_f32_16x16x32_bf16 v[24:27], v[68:71], v[84:87], v[24:27]
  v_mfma_f32_16x16x32_bf16 v[36:39], v[72:75], v[84:87], v[36:39]
  v_mfma_f32_16x16x32_bf16 v[40:43], v[68:71], v[68:71], v[40:43]
  v_mfma_f32_16x16x32_bf16 v[44:47], v[72:75], v[72:75], v[44:47]
  s_waitcnt lgkmcnt(0)
  v_mfma_f32_16x16x32_bf16 v[16:19], v[48:51], v[56:59], v[16:19]
  ds_read_b128 v[68:71], v122 offset:16384
  ds_read_b128 v[72:75], v122 offset:18432
  v_mfma_f32_16x16x32_bf16 v[28:31], v[52:55], v[56:59], v[28:31]
  ds_read_b128 v[76:79], v124 offset:6144
  ds_read_b128 v[80:83], v124 offset:8192
  v_mfma_f32_16x16x32_bf16 v[20:23], v[48:51], v[60:63], v[20:23]
  ds_read_b128 v[84:87], v124 offset:10240
  v_mfma_f32_16x16x32_bf16 v[32:35], v[52:55], v[60:63], v[32:35]
  v_mfma_f32_16x16x32_bf16 v[24:27], v[48:51], v[64:67], v[24:27]
  v_mfma_f32_16x16x32_bf16 v[36:39], v[52:55], v[64:67], v[36:39]
  v_mfma_f32_16x16x32_bf16 v[40:43], v[48:51], v[48:51], v[40:43]
  v_mfma_f32_16x16x32_bf16 v[44:47], v[52:55], v[52:55], v[44:47]
  s_waitcnt lgkmcnt(0)
  s_barrier
  v_mfma_f32_16x16x32_bf16 v[16:19], v[68:71], v[76:79], v[16:19]
  ds_read_b128 v[48:51], v121 offset:32768
  ds_read_b128 v[52:55], v121 offset:34816
  v_mfma_f32_16x16x32_bf16 v[28:31], v[72:75], v[76:79], v[28:31]
  ds_read_b128 v[56:59], v123 offset:12288
  ds_read_b128 v[60:63], v123 offset:14336
  v_mfma_f32_16x16x32_bf16 v[20:23], v[68:71], v[80:83], v[20:23]
  ds_read_b128 v[64:67], v123 offset:16384
  v_mfma_f32_16x16x32_bf16 v[32:35], v[72:75], v[80:83], v[32:35]
  v_mfma_f32_16x16x32_bf16 v[24:27], v[68:71], v[84:87], v[24:27]
  v_mfma_f32_16x16x32_bf16 v[36:39], v[72:75], v[84:87], v[36:39]
  v_mfma_f32_16x16x32_bf16 v[40:43], v[68:71], v[68:71], v[40:43]
  v_mfma_f32_16x16x32_bf16 v[44:47], v[72:75], v[72:75], v[44:47]
  s_waitcnt lgkmcnt(0)
  v_mfma_f32_16x16x32_bf16 v[16:19], v[48:51], v[56:59], v[16:19]
  ds_read_b128 v[68:71], v122 offset:32768
  ds_read_b128 v[72:75], v122 offset:34816
  v_mfma_f32_16x16x32_bf16 v[28:31], v[52:55], v[56:59], v[28:31]
  ds_read_b128 v[76:79], v124 offset:12288
  ds_read_b128 v[80:83], v124 offset:14336
  v_mfma_f32_16x16x32_bf16 v[20:23], v[48:51], v[60:63], v[20:23]
  ds_read_b128 v[84:87], v124 offset:16384
  v_mfma_f32_16x16x32_bf16 v[32:35], v[52:55], v[60:63], v[32:35]
  v_mfma_f32_16x16x32_bf16 v[24:27], v[48:51], v[64:67], v[24:27]
  v_mfma_f32_16x16x32_bf16 v[36:39], v[52:55], v[64:67], v[36:39]
  v_mfma_f32_16x16x32_bf16 v[40:43], v[48:51], v[48:51], v[40:43]
  v_mfma_f32_16x16x32_bf16 v[44:47], v[52:55], v[52:55], v[44:47]
  s_waitcnt lgkmcnt(0)
  s_barrier
  v_mfma_f32_16x16x32_bf16 v[16:19], v[68:71], v[76:79], v[16:19]
  ds_read_b128 v[48:51], v121 offset:49152
  ds_read_b128 v[52:55], v121 offset:51200
  v_mfma_f32_16x16x32_bf16 v[28:31], v[72:75], v[76:79], v[28:31]
  ds_read_b128 v[56:59], v123 offset:18432
  ds_read_b128 v[60:63], v123 offset:20480
  v_mfma_f32_16x16x32_bf16 v[20:23], v[68:71], v[80:83], v[20:23]
  ds_read_b128 v[64:67], v123 offset:22528
  v_mfma_f32_16x16x32_bf16 v[32:35], v[72:75], v[80:83], v[32:35]
  v_mfma_f32_16x16x32_bf16 v[24:27], v[68:71], v[84:87], v[24:27]
  v_mfma_f32_16x16x32_bf16 v[36:39], v[72:75], v[84:87], v[36:39]
  v_mfma_f32_16x16x32_bf16 v[40:43], v[68:71], v[68:71], v[40:43]
  v_mfma_f32_16x16x32_bf16 v[44:47], v[72:75], v[72:75], v[44:47]
  s_waitcnt lgkmcnt(0)
  v_mfma_f32_16x16x32_bf16 v[16:19], v[48:51], v[56:59], v[16:19]
  ds_read_b128 v[68:71], v122 offset:49152
  ds_read_b128 v[72:75], v122 offset:51200
  v_mfma_f32_16x16x32_bf16 v[28:31], v[52:55], v[56:59], v[28:31]
  ds_read_b128 v[76:79], v124 offset:18432
  ds_read_b128 v[80:83], v124 offset:20480
  v_mfma_f32_16x16x32_bf16 v[20:23], v[48:51], v[60:63], v[20:23]
  ds_read_b128 v[84:87], v124 offset:22528
  v_mfma_f32_16x16x32_bf16 v[32:35], v[52:55], v[60:63], v[32:35]
  v_mfma_f32_16x16x32_bf16 v[24:27], v[48:51], v[64:67], v[24:27]
  v_mfma_f32_16x16x32_bf16 v[36:39], v[52:55], v[64:67], v[36:39]
  v_mfma_f32_16x16x32_bf16 v[40:43], v[48:51], v[48:51], v[40:43]
  v_mfma_f32_16x16x32_bf16 v[44:47], v[52:55], v[52:55], v[44:47]
  s_waitcnt lgkmcnt(0)
  s_barrier
  v_mfma_f32_16x16x32_bf16 v[16:19], v[68:71], v[76:79], v[16:19]
  ds_read_b128 v[48:51], v121 offset:0
  ds_read_b128 v[52:55], v121 offset:2048
  v_mfma_f32_16x16x32_bf16 v[28:31], v[72:75], v[76:79], v[28:31]
  ds_read_b128 v[56:59], v123 offset:0
  ds_read_b128 v[60:63], v123 offset:2048
  v_mfma_f32_16x16x32_bf16 v[20:23], v[68:71], v[80:83], v[20:23]
  ds_read_b128 v[64:67], v123 offset:4096
  v_mfma_f32_16x16x32_bf16 v[32:35], v[72:75], v[80:83], v[32:35]
  v_mfma_f32_16x16x32_bf16 v[24:27], v[68:71], v[84:87], v[24:27]
  v_mfma_f32_16x16x32_bf16 v[36:39], v[72:75], v[84:87], v[36:39]
  v_mfma_f32_16x16x32_bf16 v[40:43], v[68:71], v[68:71], v[40:43]
  v_mfma_f32_16x16x32_bf16 v[44:47], v[72:75], v[72:75], v[44:47]
  s_waitcnt lgkmcnt(0)
  v_mfma_f32_16x16x32_bf16 v[16:19], v[48:51], v[56:59], v[16:19]
  ds_read_b128 v[68:71], v122 offset:0
  ds_read_b128 v[72:75], v122 offset:2048
  v_mfma_f32_16x16x32_bf16 v[28:31], v[52:55], v[56:59], v[28:31]
  ds_read_b128 v[76:79], v124 offset:0
  ds_read_b128 v[80:83], v124 offset:2048
  v_mfma_f32_16x16x32_bf16 v[20:23], v[48:51], v[60:63], v[20:23]
  ds_read_b128 v[84:87], v124 offset:4096
  v_mfma_f32_16x16x32_bf16 v[32:35], v[52:55], v[60:63], v[32:35]
  v_mfma_f32_16x16x32_bf16 v[24:27], v[48:51], v[64:67], v[24:27]
  v_mfma_f32_16x16x32_bf16 v[36:39], v[52:55], v[64:67], v[36:39]
  v_mfma_f32_16x16x32_bf16 v[40:43], v[48:51], v[48:51], v[40:43]
  v_mfma_f32_16x16x32_bf16 v[44:47], v[52:55], v[52:55], v[44:47]
  s_waitcnt lgkmcnt(0)
  s_barrier
  v_mfma_f32_16x16x32_bf16 v[16:19], v[68:71], v[76:79], v[16:19]
  ds_read_b128 v[48:51], v121 offset:16384
  ds_read_b128 v[52:55], v121 offset:18432
  v_mfma_f32_16x16x32_bf16 v[28:31], v[72:75], v[76:79], v[28:31]
  ds_read_b128 v[56:59], v123 offset:6144
  ds_read_b128 v[60:63], v123 offset:8192
  v_mfma_f32_16x16x32_bf16 v[20:23], v[68:71], v[80:83], v[20:23]
  ds_read_b128 v[64:67], v123 offset:10240
  v_mfma_f32_16x16x32_bf16 v[32:35], v[72:75], v[80:83], v[32:35]
  v_mfma_f32_16x16x32_bf16 v[24:27], v[68:71], v[84:87], v[24:27]
  v_mfma_f32_16x16x32_bf16 v[36:39], v[72:75], v[84:87], v[36:39]
  v_mfma_f32_16x16x32_bf16 v[40:43], v[68:71], v[68:71], v[40:43]
  v_mfma_f32_16x16x32_bf16 v[44:47], v[72:75], v[72:75], v[44:47]
  s_waitcnt lgkmcnt(0)
  v_mfma_f32_16x16x32_bf16 v[16:19], v[48:51], v[56:59], v[16:19]
  ds_read_b128 v[68:71], v122 offset:16384
  ds_read_b128 v[72:75], v122 offset:18432
  v_mfma_f32_16x16x32_bf16 v[28:31], v[52:55], v[56:59], v[28:31]
  ds_read_b128 v[76:79], v124 offset:6144
  ds_read_b128 v[80:83], v124 offset:8192
  v_mfma_f32_16x16x32_bf16 v[20:23], v[48:51], v[60:63], v[20:23]
  ds_read_b128 v[84:87], v124 offset:10240
  v_mfma_f32_16x16x32_bf16 v[32:35], v[52:55], v[60:63], v[32:35]
  v_mfma_f32_16x16x32_bf16 v[24:27], v[48:51], v[64:67], v[24:27]
  v_mfma_f32_16x16x32_bf16 v[36:39], v[52:55], v[64:67], v[36:39]
  v_mfma_f32_16x16x32_bf16 v[40:43], v[48:51], v[48:51], v[40:43]
  v_mfma_f32_16x16x32_bf16 v[44:47], v[52:55], v[52:55], v[44:47]
  s_waitcnt lgkmcnt(0)
  v_mfma_f32_16x16x32_bf16 v[16:19], v[68:71], v[76:79], v[16:19]
  v_mfma_f32_16x16x32_bf16 v[28:31], v[72:75], v[76:79], v[28:31]
  v_mfma_f32_16x16x32_bf16 v[20:23], v[68:71], v[80:83], v[20:23]
  v_mfma_f32_16x16x32_bf16 v[32:35], v[72:75], v[80:83], v[32:35]
  v_mfma_f32_16x16x32_bf16 v[24:27], v[68:71], v[84:87], v[24:27]
  v_mfma_f32_16x16x32_bf16 v[36:39], v[72:75], v[84:87], v[36:39]
  v_mfma_f32_16x16x32_bf16 v[40:43], v[68:71], v[68:71], v[40:43]
  v_mfma_f32_16x16x32_bf16 v[44:47], v[72:75], v[72:75], v[44:47]
  s_setprio 1
  s_lshl_b32 s40, s4, 8
  s_add_u32 s40, s40, 147456
  v_lshlrev_b32 v6, 2, v2
  v_add_u32 v6, s40, v6
  v_lshlrev_b32 v7, 4, v3
  v_add_u32 v7, s40, v7
  s_mov_b32 s58, 0xaaaaaaaa
  s_mov_b32 s59, 0xaaaaaaaa
  s_mov_b32 s60, 0xcccccccc
  s_mov_b32 s61, 0xcccccccc
  s_nop 2
  v_cndmask_b32_e64 v8, v40, v41, s[58:59]
  v_cndmask_b32_e64 v9, v42, v43, s[58:59]
  v_cndmask_b32_e64 v10, v8, v9, s[60:61]
  v_cndmask_b32_e64 v8, v44, v45, s[58:59]
  v_cndmask_b32_e64 v9, v46, v47, s[58:59]
  v_cndmask_b32_e64 v11, v8, v9, s[60:61]
  s_mov_b32 exec_lo, 0x00f0000f
  s_mov_b32 exec_hi, 0xf0000f00
  ds_write_b32 v6, v10 offset:128
  ds_write_b32 v6, v11 offset:192
  s_mov_b32 exec_lo, 0x00100010
  s_mov_b32 exec_hi, 0x00100010
  ds_write_b128 v7, v[24:27] offset:0
  ds_write_b128 v7, v[36:39] offset:64
  s_mov_b64 exec, -1
  s_waitcnt lgkmcnt(0)
  s_barrier
  ds_read_b128 v[48:51], v7 offset:0
  ds_read_b128 v[56:59], v7 offset:128
  ds_read_b128 v[52:55], v7 offset:64
  ds_read_b128 v[60:63], v7 offset:192
  s_mov_b32 s40, 0x3acccccd
  s_mov_b32 s41, 0x3727c5ac
  s_waitcnt lgkmcnt(0)
  v_mul_f32 v48, s40, v48
  v_mul_f32 v56, s40, v56
  v_fma_f32 v56, -v48, v48, v56
  v_add_f32 v56, s41, v56
  v_rsq_f32 v56, v56
  v_mul_f32 v49, s40, v49
  v_mul_f32 v57, s40, v57
  v_fma_f32 v57, -v49, v49, v57
  v_add_f32 v57, s41, v57
  v_rsq_f32 v57, v57
  v_mul_f32 v50, s40, v50
  v_mul_f32 v58, s40, v58
  v_fma_f32 v58, -v50, v50, v58
  v_add_f32 v58, s41, v58
  v_rsq_f32 v58, v58
  v_mul_f32 v51, s40, v51
  v_mul_f32 v59, s40, v59
  v_fma_f32 v59, -v51, v51, v59
  v_add_f32 v59, s41, v59
  v_rsq_f32 v59, v59
  v_mul_f32 v52, s40, v52
  v_mul_f32 v60, s40, v60
  v_fma_f32 v60, -v52, v52, v60
  v_add_f32 v60, s41, v60
  v_rsq_f32 v60, v60
  v_mul_f32 v53, s40, v53
  v_mul_f32 v61, s40, v61
  v_fma_f32 v61, -v53, v53, v61
  v_add_f32 v61, s41, v61
  v_rsq_f32 v61, v61
  v_mul_f32 v54, s40, v54
  v_mul_f32 v62, s40, v62
  v_fma_f32 v62, -v54, v54, v62
  v_add_f32 v62, s41, v62
  v_rsq_f32 v62, v62
  v_mul_f32 v55, s40, v55
  v_mul_f32 v63, s40, v63
  v_fma_f32 v63, -v55, v55, v63
  v_add_f32 v63, s41, v63
  v_rsq_f32 v63, v63
  s_nop 0
  v_pk_mul_f32 v[16:17], v[16:17], v[56:57]
  v_pk_mul_f32 v[18:19], v[18:19], v[58:59]
  v_pk_mul_f32 v[28:29], v[28:29], v[60:61]
  v_pk_mul_f32 v[30:31], v[30:31], v[62:63]
  v_cvt_pk_bf16_f32 v64, v16, v17
  v_cvt_pk_bf16_f32 v65, v18, v19
  v_cvt_pk_bf16_f32 v66, v28, v29
  v_cvt_pk_bf16_f32 v67, v30, v31
  v_pk_mul_f32 v[20:21], v[20:21], v[56:57]
  v_pk_mul_f32 v[22:23], v[22:23], v[58:59]
  v_pk_mul_f32 v[32:33], v[32:33], v[60:61]
  v_pk_mul_f32 v[34:35], v[34:35], v[62:63]
  v_cvt_pk_bf16_f32 v68, v20, v21
  v_cvt_pk_bf16_f32 v69, v22, v23
  v_cvt_pk_bf16_f32 v70, v32, v33
  v_cvt_pk_bf16_f32 v71, v34, v35
  v_pk_mul_f32 v[24:25], v[24:25], v[56:57]
  v_pk_mul_f32 v[26:27], v[26:27], v[58:59]
  v_pk_mul_f32 v[36:37], v[36:37], v[60:61]
  v_pk_mul_f32 v[38:39], v[38:39], v[62:63]
  v_cvt_pk_bf16_f32 v72, v24, v25
  v_cvt_pk_bf16_f32 v73, v26, v27
  v_cvt_pk_bf16_f32 v74, v36, v37
  v_cvt_pk_bf16_f32 v75, v38, v39
  s_nop 1
  v_mfma_f32_16x16x32_bf16 v[16:19], v[88:91], v[64:67], 0
  v_mfma_f32_16x16x32_bf16 v[24:27], v[96:99], v[64:67], 0
  v_mfma_f32_16x16x32_bf16 v[32:35], v[88:91], v[72:75], 0
  v_mfma_f32_16x16x32_bf16 v[40:43], v[96:99], v[72:75], 0
  v_mfma_f32_16x16x32_bf16 v[20:23], v[92:95], v[64:67], 0
  v_mfma_f32_16x16x32_bf16 v[28:31], v[100:103], v[64:67], 0
  v_mfma_f32_16x16x32_bf16 v[36:39], v[92:95], v[72:75], 0
  v_mfma_f32_16x16x32_bf16 v[44:47], v[100:103], v[72:75], 0
  v_mfma_f32_16x16x32_bf16 v[16:19], v[96:99], v[68:71], v[16:19]
  v_mfma_f32_16x16x32_bf16 v[24:27], v[104:107], v[68:71], v[24:27]
  v_mfma_f32_16x16x32_bf16 v[20:23], v[100:103], v[68:71], v[20:23]
  v_mfma_f32_16x16x32_bf16 v[28:31], v[108:111], v[68:71], v[28:31]
  s_mul_i32 s40, s5, 320
  s_mul_i32 s41, s6, 20
  s_add_u32 s40, s40, s41
  s_lshl_b32 s40, s40, 4
  s_add_u32 s40, s40, 0x600000
  s_nop 4
  v_add_f32_dpp v48, v40, v32 row_shl:8 row_mask:0xf bank_mask:0xf bound_ctrl:0
  v_subrev_f32_dpp v52, v32, v40 row_shl:8 row_mask:0xf bank_mask:0xf bound_ctrl:0
  v_add_f32_dpp v49, v41, v33 row_shl:8 row_mask:0xf bank_mask:0xf bound_ctrl:0
  v_subrev_f32_dpp v53, v33, v41 row_shl:8 row_mask:0xf bank_mask:0xf bound_ctrl:0
  v_add_f32_dpp v50, v42, v34 row_shl:8 row_mask:0xf bank_mask:0xf bound_ctrl:0
  v_subrev_f32_dpp v54, v34, v42 row_shl:8 row_mask:0xf bank_mask:0xf bound_ctrl:0
  v_add_f32_dpp v51, v43, v35 row_shl:8 row_mask:0xf bank_mask:0xf bound_ctrl:0
  v_subrev_f32_dpp v55, v35, v43 row_shl:8 row_mask:0xf bank_mask:0xf bound_ctrl:0
  v_add_f32_dpp v56, v44, v36 row_shl:8 row_mask:0xf bank_mask:0xf bound_ctrl:0
  v_subrev_f32_dpp v60, v36, v44 row_shl:8 row_mask:0xf bank_mask:0xf bound_ctrl:0
  v_add_f32_dpp v57, v45, v37 row_shl:8 row_mask:0xf bank_mask:0xf bound_ctrl:0
  v_subrev_f32_dpp v61, v37, v45 row_shl:8 row_mask:0xf bank_mask:0xf bound_ctrl:0
  v_add_f32_dpp v58, v46, v38 row_shl:8 row_mask:0xf bank_mask:0xf bound_ctrl:0
  v_subrev_f32_dpp v62, v38, v46 row_shl:8 row_mask:0xf bank_mask:0xf bound_ctrl:0
  v_add_f32_dpp v59, v47, v39 row_shl:8 row_mask:0xf bank_mask:0xf bound_ctrl:0
  v_subrev_f32_dpp v63, v39, v47 row_shl:8 row_mask:0xf bank_mask:0xf bound_ctrl:0
  v_cvt_pk_bf16_f32 v128, v16, v24
  v_cvt_pk_bf16_f32 v129, v17, v25
  v_cvt_pk_bf16_f32 v130, v18, v26
  v_cvt_pk_bf16_f32 v131, v19, v27
  v_cvt_pk_bf16_f32 v132, v20, v28
  v_cvt_pk_bf16_f32 v133, v21, v29
  v_cvt_pk_bf16_f32 v134, v22, v30
  v_cvt_pk_bf16_f32 v135, v23, v31
  ds_write_b32 v125, v128 offset:0
  ds_write_b32 v125, v129 offset:320
  ds_write_b32 v125, v130 offset:640
  ds_write_b32 v125, v131 offset:960
  ds_write_b32 v125, v132 offset:5120
  ds_write_b32 v125, v133 offset:5440
  ds_write_b32 v125, v134 offset:5760
  ds_write_b32 v125, v135 offset:6080
  v_cvt_pk_bf16_f32 v136, v48, v52
  v_cvt_pk_bf16_f32 v137, v49, v53
  v_cvt_pk_bf16_f32 v138, v50, v54
  v_cvt_pk_bf16_f32 v139, v51, v55
  v_cvt_pk_bf16_f32 v140, v56, v60
  v_cvt_pk_bf16_f32 v141, v57, v61
  v_cvt_pk_bf16_f32 v142, v58, v62
  v_cvt_pk_bf16_f32 v143, v59, v63
  s_mov_b32 exec_lo, 0x000f000f
  s_mov_b32 exec_hi, 0x000f000f
  ds_write_b32 v125, v136 offset:256
  ds_write_b32 v125, v137 offset:576
  ds_write_b32 v125, v138 offset:896
  ds_write_b32 v125, v139 offset:1216
  ds_write_b32 v125, v140 offset:5376
  ds_write_b32 v125, v141 offset:5696
  ds_write_b32 v125, v142 offset:6016
  ds_write_b32 v125, v143 offset:6336
  s_mov_b64 exec, -1
  s_waitcnt lgkmcnt(0)
  s_barrier
  s_cmp_ge_u32 s4, 2
  ds_read_b128 v[16:19], v112
  ds_read_b128 v[20:23], v113
  s_cbranch_scc1 L1_B2
  ds_read_b128 v[24:27], v114
  s_waitcnt lgkmcnt(0)
  buffer_store_dwordx4 v[24:27], v117, s[24:27], s40 offen sc1
L1_B2:
  s_waitcnt lgkmcnt(0)
  buffer_store_dwordx4 v[16:19], v115, s[24:27], s40 offen sc1
  buffer_store_dwordx4 v[20:23], v116, s[24:27], s40 offen sc1
  s_endpgm
L1_L:
  s_setprio 3
  v_lshrrev_b32 v6, 3, v1
  v_and_b32 v7, 7, v1
  v_xor_b32 v8, v7, v3
  v_lshlrev_b32 v8, 4, v8
  s_mov_b32 s40, 81920
  v_mul_lo_u32 v9, v6, s40
  v_add_u32 v9, v9, v8
  s_mul_i32 s41, s7, 1280
  s_add_u32 s42, s41, 0
  v_add_u32 v112, s42, v9
  s_add_u32 s42, s41, 654336
  v_xor_b32 v10, 64, v9
  v_add_u32 v113, s42, v10
  s_add_u32 s42, s41, 1308672
  v_add_u32 v114, s42, v9
  s_add_u32 s42, s41, 1963008
  v_xor_b32 v10, 64, v9
  v_add_u32 v115, s42, v10
  s_mul_i32 s41, s4, 49152
  s_mul_i32 s42, s6, 192
  s_add_u32 s41, s41, s42
  v_add_u32 v10, 0, v1
  v_mul_u32_u24 v11, 171, v10
  v_lshrrev_b32 v11, 11, v11
  v_mul_u32_u24 v12, 12, v11
  v_sub_u32 v12, v10, v12
  v_lshrrev_b32 v13, 3, v11
  v_lshlrev_b32 v13, 1, v13
  v_xor_b32 v12, v12, v13
  v_mul_u32_u24 v11, 3072, v11
  v_lshl_add_u32 v11, v12, 4, v11
  s_sub_u32 s42, s41, 0
  v_add_u32 v116, s42, v11
  v_add_u32 v10, 64, v1
  v_mul_u32_u24 v11, 171, v10
  v_lshrrev_b32 v11, 11, v11
  v_mul_u32_u24 v12, 12, v11
  v_sub_u32 v12, v10, v12
  v_lshrrev_b32 v13, 3, v11
  v_lshlrev_b32 v13, 1, v13
  v_xor_b32 v12, v12, v13
  v_mul_u32_u24 v11, 3072, v11
  v_lshl_add_u32 v11, v12, 4, v11
  s_sub_u32 s42, s41, 1024
  v_add_u32 v117, s42, v11
  v_add_u32 v10, 128, v1
  v_mul_u32_u24 v11, 171, v10
  v_lshrrev_b32 v11, 11, v11
  v_mul_u32_u24 v12, 12, v11
  v_sub_u32 v12, v10, v12
  v_lshrrev_b32 v13, 3, v11
  v_lshlrev_b32 v13, 1, v13
  v_xor_b32 v12, v12, v13
  v_mul_u32_u24 v11, 3072, v11
  v_lshl_add_u32 v11, v12, 4, v11
  s_sub_u32 s42, s41, 2048
  v_add_u32 v118, s42, v11
  s_and_b32 s41, s4, 1
  s_mul_i32 s42, s6, 20
  s_lshl_b32 s43, s41, 3
  s_add_u32 s43, s43, s42
  v_add_u32 v10, s43, v6
  v_mov_b32 v11, 320
  v_cmp_eq_u32 vcc, 0, v10
  s_lshl_b32 s43, s41, 6
  v_xor_b32 v12, s43, v8
  v_cndmask_b32 v10, v10, v11, vcc
  v_mul_u32_u24 v10, 1280, v10
  v_add_u32 v119, v10, v12
  s_add_u32 s43, s42, 16
  v_add_u32 v10, s43, v6
  v_and_b32 v10, 0x1ff, v10
  s_cmp_eq_u32 s4, 1
  s_cselect_b32 s43, 0, 1280
  v_mul_lo_u32 v10, v10, s43
  s_lshl_b32 s43, s4, 1
  v_add_u32 v11, s43, v3
  v_and_b32 v11, 7, v11
  v_xor_b32 v11, v11, v7
  v_lshl_add_u32 v120, v11, 4, v10
  s_lshl_b32 s50, s4, 12
  s_mul_i32 s51, s4, 3072
  s_add_u32 s51, s51, 65536
  s_lshl_b32 s52, s4, 10
  s_add_u32 s52, s52, 114688
  s_lshl_b32 s53, s4, 9
  s_add_u32 s53, s53, 118784
  s_waitcnt lgkmcnt(0)
  s_mov_b32 s8, s28
  s_mov_b32 s9, s29
  s_mov_b32 s10, 0x280000
  s_mov_b32 s11, 0x00020000
  s_mov_b32 s12, s34
  s_mov_b32 s13, s35
  s_mov_b32 s14, 0x1e0000
  s_mov_b32 s15, 0x00020000
  s_cmp_ge_u32 s4, 2
  s_cselect_b32 s16, s32, s30
  s_cselect_b32 s17, s33, s31
  s_mov_b32 s18, 819200
  s_mov_b32 s19, 0x00020000
  s_mov_b32 s20, s36
  s_mov_b32 s21, s37
  s_mov_b32 s22, 0x1e0000
  s_mov_b32 s23, 0x00020000
  s_mov_b32 s24, s38
  s_mov_b32 s25, s39
  s_mov_b32 s26, 0xa60000
  s_mov_b32 s27, 0x00020000
  s_lshr_b32 s40, s2, 5
  s_mul_i32 s40, s40, 0
  s_lshr_b32 s41, s2, 3
  s_and_b32 s41, s41, 3
  s_mul_i32 s41, s41, 0
  s_add_u32 s40, s40, s41
  s_lshr_b32 s41, s2, 1
  s_and_b32 s41, s41, 3
  s_mul_i32 s41, s41, 3
  s_add_u32 s40, s40, s41
  s_and_b32 s41, s2, 1
  s_mul_i32 s41, s41, 5
  s_add_u32 s40, s40, s41
  s_mul_i32 s41, s40, 205
  s_lshr_b32 s41, s41, 11
  s_mul_i32 s41, s41, 10
  s_sub_u32 s62, s40, s41
  s_add_u32 s63, s62, 0
  s_cmp_ge_u32 s63, 10
  s_cselect_b32 s54, 10, 0
  s_sub_u32 s63, s63, s54
  s_lshl_b32 s54, s63, 7
  s_mul_i32 s55, s63, 196608
  s_add_u32 m0, s50, 0
  s_nop 0
  buffer_load_dwordx4 v112, s[8:11], s54 offen lds
  buffer_load_dwordx4 v113, s[8:11], s54 offen offset:1024 lds
  buffer_load_dwordx4 v114, s[8:11], s54 offen offset:2048 lds
  buffer_load_dwordx4 v115, s[8:11], s54 offen offset:3072 lds
  s_add_u32 m0, s51, 0
  s_nop 0
  buffer_load_dwordx4 v116, s[12:15], s55 offen lds
  buffer_load_dwordx4 v117, s[12:15], s55 offen offset:1024 lds
  buffer_load_dwordx4 v118, s[12:15], s55 offen offset:2048 lds
  s_add_u32 m0, s52, 0
  s_nop 0
  buffer_load_dwordx4 v119, s[16:19], s54 offen lds
  s_add_u32 m0, s53, 0
  s_mov_b32 exec_hi, 0
  buffer_load_dwordx4 v120, s[16:19], s54 offen lds
  s_mov_b32 exec_hi, -1
  s_add_u32 s63, s62, 1
  s_cmp_ge_u32 s63, 10
  s_cselect_b32 s54, 10, 0
  s_sub_u32 s63, s63, s54
  s_lshl_b32 s54, s63, 7
  s_mul_i32 s55, s63, 196608
  s_add_u32 m0, s50, 16384
  s_nop 0
  buffer_load_dwordx4 v112, s[8:11], s54 offen lds
  buffer_load_dwordx4 v113, s[8:11], s54 offen offset:1024 lds
  buffer_load_dwordx4 v114, s[8:11], s54 offen offset:2048 lds
  buffer_load_dwordx4 v115, s[8:11], s54 offen offset:3072 lds
  s_add_u32 m0, s51, 12288
  s_nop 0
  buffer_load_dwordx4 v116, s[12:15], s55 offen lds
  buffer_load_dwordx4 v117, s[12:15], s55 offen offset:1024 lds
  buffer_load_dwordx4 v118, s[12:15], s55 offen offset:2048 lds
  s_add_u32 m0, s52, 6144
  s_nop 0
  buffer_load_dwordx4 v119, s[16:19], s54 offen lds
  s_add_u32 m0, s53, 6144
  s_mov_b32 exec_hi, 0
  buffer_load_dwordx4 v120, s[16:19], s54 offen lds
  s_mov_b32 exec_hi, -1
  s_lshr_b32 s43, s2, 3
  s_cmp_ge_u32 s43, 30
  s_cselect_b32 s47, 30, 0
  s_sub_u32 s43, s43, s47
  s_lshl_b32 s43, s43, 2
  s_add_u32 s43, s43, s4
  s_mul_i32 s47, s43, 6554
  s_lshr_b32 s47, s47, 16
  s_mul_i32 s48, s47, 10
  s_sub_u32 s43, s43, s48
  s_lshr_b32 s48, s2, 1
  s_and_b32 s48, s48, 3
  s_mul_i32 s48, s48, 12
  s_add_u32 s48, s48, s47
  s_add_u32 s47, s43, 10
  s_cmp_lt_u32 s43, 5
  s_cselect_b32 s47, s43, s47
  s_add_u32 s43, s43, 5
  s_bitcmp1_b32 s2, 0
  s_cselect_b32 s47, s43, s47
  v_lshrrev_b32 v10, 2, v1
  v_mul_u32_u24 v10, 1280, v10
  v_and_b32 v11, 3, v1
  v_lshl_add_u32 v10, v11, 4, v10
  s_mul_i32 s43, s48, 40960
  s_lshl_b32 s49, s47, 6
  s_add_u32 s43, s43, s49
  v_add_u32 v125, s43, v10
  s_lshl_b32 s56, s4, 11
  s_add_u32 s56, s56, 139264
  s_mov_b32 s57, 19456
  v_lshrrev_b32 v8, 2, v2
  v_lshl_add_u32 v8, v3, 2, v8
  v_lshlrev_b32 v8, 6, v8
  v_and_b32 v9, 3, v2
  v_lshl_add_u32 v8, v9, 3, v8
  v_add_u32 v8, s56, v8
  v_lshlrev_b32 v9, 4, v1
  s_lshl_b32 s40, s47, 1
  s_mul_i32 s40, s40, 48
  s_add_u32 s40, s40, s48
  s_lshl_b32 s40, s40, 10
  s_add_u32 s40, s40, 0x880000
  s_add_u32 s41, s40, 49152
  s_waitcnt vmcnt(9)
  s_barrier
  s_add_u32 s63, s62, 2
  s_cmp_ge_u32 s63, 10
  s_cselect_b32 s54, 10, 0
  s_sub_u32 s63, s63, s54
  s_lshl_b32 s54, s63, 7
  s_mul_i32 s55, s63, 196608
  s_add_u32 m0, s50, 32768
  s_nop 0
  buffer_load_dwordx4 v112, s[8:11], s54 offen lds
  buffer_load_dwordx4 v113, s[8:11], s54 offen offset:1024 lds
  buffer_load_dwordx4 v114, s[8:11], s54 offen offset:2048 lds
  buffer_load_dwordx4 v115, s[8:11], s54 offen offset:3072 lds
  s_add_u32 m0, s51, 24576
  s_nop 0
  buffer_load_dwordx4 v116, s[12:15], s55 offen lds
  buffer_load_dwordx4 v117, s[12:15], s55 offen offset:1024 lds
  buffer_load_dwordx4 v118, s[12:15], s55 offen offset:2048 lds
  s_add_u32 m0, s52, 12288
  s_nop 0
  buffer_load_dwordx4 v119, s[16:19], s54 offen lds
  s_add_u32 m0, s53, 12288
  s_mov_b32 exec_hi, 0
  buffer_load_dwordx4 v120, s[16:19], s54 offen lds
  s_mov_b32 exec_hi, -1
  s_waitcnt vmcnt(9)
  s_barrier
  s_add_u32 s63, s62, 3
  s_cmp_ge_u32 s63, 10
  s_cselect_b32 s54, 10, 0
  s_sub_u32 s63, s63, s54
  s_lshl_b32 s54, s63, 7
  s_mul_i32 s55, s63, 196608
  s_add_u32 m0, s50, 49152
  s_nop 0
  buffer_load_dwordx4 v112, s[8:11], s54 offen lds
  buffer_load_dwordx4 v113, s[8:11], s54 offen offset:1024 lds
  buffer_load_dwordx4 v114, s[8:11], s54 offen offset:2048 lds
  buffer_load_dwordx4 v115, s[8:11], s54 offen offset:3072 lds
  s_add_u32 m0, s51, 36864
  s_nop 0
  buffer_load_dwordx4 v116, s[12:15], s55 offen lds
  buffer_load_dwordx4 v117, s[12:15], s55 offen offset:1024 lds
  buffer_load_dwordx4 v118, s[12:15], s55 offen offset:2048 lds
  s_add_u32 m0, s52, 18432
  s_nop 0
  buffer_load_dwordx4 v119, s[16:19], s54 offen lds
  s_add_u32 m0, s53, 18432
  s_mov_b32 exec_hi, 0
  buffer_load_dwordx4 v120, s[16:19], s54 offen lds
  s_mov_b32 exec_hi, -1
  s_add_u32 s63, s62, 4
  s_cmp_ge_u32 s63, 10
  s_cselect_b32 s54, 10, 0
  s_sub_u32 s63, s63, s54
  s_lshl_b32 s54, s63, 7
  s_mul_i32 s55, s63, 196608
  s_add_u32 m0, s50, 0
  s_nop 0
  buffer_load_dwordx4 v112, s[8:11], s54 offen lds
  buffer_load_dwordx4 v113, s[8:11], s54 offen offset:1024 lds
  buffer_load_dwordx4 v114, s[8:11], s54 offen offset:2048 lds
  s_waitcnt vmcnt(12)
  s_barrier
  buffer_load_dwordx4 v115, s[8:11], s54 offen offset:3072 lds
  s_add_u32 m0, s51, 0
  s_nop 0
  buffer_load_dwordx4 v116, s[12:15], s55 offen lds
  buffer_load_dwordx4 v117, s[12:15], s55 offen offset:1024 lds
  buffer_load_dwordx4 v118, s[12:15], s55 offen offset:2048 lds
  s_add_u32 m0, s52, 0
  s_nop 0
  buffer_load_dwordx4 v119, s[16:19], s54 offen lds
  s_add_u32 m0, s53, 0
  s_mov_b32 exec_hi, 0
  buffer_load_dwordx4 v120, s[16:19], s54 offen lds
  s_mov_b32 exec_hi, -1
  s_add_u32 s63, s62, 5
  s_cmp_ge_u32 s63, 10
  s_cselect_b32 s54, 10, 0
  s_sub_u32 s63, s63, s54
  s_lshl_b32 s54, s63, 7
  s_mul_i32 s55, s63, 196608
  s_add_u32 m0, s50, 16384
  s_nop 0
  buffer_load_dwordx4 v112, s[8:11], s54 offen lds
  buffer_load_dwordx4 v113, s[8:11], s54 offen offset:1024 lds
  buffer_load_dwordx4 v114, s[8:11], s54 offen offset:2048 lds
  buffer_load_dwordx4 v115, s[8:11], s54 offen offset:3072 lds
  s_add_u32 m0, s51, 12288
  s_nop 0
  buffer_load_dwordx4 v116, s[12:15], s55 offen lds
  buffer_load_dwordx4 v117, s[12:15], s55 offen offset:1024 lds
  s_waitcnt vmcnt(15)
  s_barrier
  buffer_load_dwordx4 v118, s[12:15], s55 offen offset:2048 lds
  s_add_u32 m0, s52, 6144
  s_nop 0
  buffer_load_dwordx4 v119, s[16:19], s54 offen lds
  s_add_u32 m0, s53, 6144
  s_mov_b32 exec_hi, 0
  buffer_load_dwordx4 v120, s[16:19], s54 offen lds
  s_mov_b32 exec_hi, -1
  s_add_u32 s63, s62, 6
  s_cmp_ge_u32 s63, 10
  s_cselect_b32 s54, 10, 0
  s_sub_u32 s63, s63, s54
  s_lshl_b32 s54, s63, 7
  s_mul_i32 s55, s63, 196608
  s_add_u32 m0, s50, 32768
  s_nop 0
  buffer_load_dwordx4 v112, s[8:11], s54 offen lds
  buffer_load_dwordx4 v113, s[8:11], s54 offen offset:1024 lds
  buffer_load_dwordx4 v114, s[8:11], s54 offen offset:2048 lds
  buffer_load_dwordx4 v115, s[8:11], s54 offen offset:3072 lds
  s_add_u32 m0, s51, 24576
  s_nop 0
  buffer_load_dwordx4 v116, s[12:15], s55 offen lds
  buffer_load_dwordx4 v117, s[12:15], s55 offen offset:1024 lds
  buffer_load_dwordx4 v118, s[12:15], s55 offen offset:2048 lds
  s_add_u32 m0, s52, 12288
  s_nop 0
  buffer_load_dwordx4 v119, s[16:19], s54 offen lds
  s_add_u32 m0, s53, 12288
  s_mov_b32 exec_hi, 0
  buffer_load_dwordx4 v120, s[16:19], s54 offen lds
  s_mov_b32 exec_hi, -1
  s_waitcnt vmcnt(18)
  s_barrier
  s_add_u32 s63, s62, 7
  s_cmp_ge_u32 s63, 10
  s_cselect_b32 s54, 10, 0
  s_sub_u32 s63, s63, s54
  s_lshl_b32 s54, s63, 7
  s_mul_i32 s55, s63, 196608
  s_add_u32 m0, s50, 49152
  s_nop 0
  buffer_load_dwordx4 v112, s[8:11], s54 offen lds
  buffer_load_dwordx4 v113, s[8:11], s54 offen offset:1024 lds
  buffer_load_dwordx4 v114, s[8:11], s54 offen offset:2048 lds
  buffer_load_dwordx4 v115, s[8:11], s54 offen offset:3072 lds
  s_add_u32 m0, s51, 36864
  s_nop 0
  buffer_load_dwordx4 v116, s[12:15], s55 offen lds
  buffer_load_dwordx4 v117, s[12:15], s55 offen offset:1024 lds
  buffer_load_dwordx4 v118, s[12:15], s55 offen offset:2048 lds
  s_add_u32 m0, s52, 18432
  s_nop 0
  buffer_load_dwordx4 v119, s[16:19], s54 offen lds
  s_add_u32 m0, s53, 18432
  s_mov_b32 exec_hi, 0
  buffer_load_dwordx4 v120, s[16:19], s54 offen lds
  s_mov_b32 exec_hi, -1
  s_waitcnt vmcnt(18)
  s_barrier
  s_add_u32 s63, s62, 8
  s_cmp_ge_u32 s63, 10
  s_cselect_b32 s54, 10, 0
  s_sub_u32 s63, s63, s54
  s_lshl_b32 s54, s63, 7
  s_mul_i32 s55, s63, 196608
  s_add_u32 m0, s50, 0
  s_nop 0
  buffer_load_dwordx4 v112, s[8:11], s54 offen lds
  buffer_load_dwordx4 v113, s[8:11], s54 offen offset:1024 lds
  buffer_load_dwordx4 v114, s[8:11], s54 offen offset:2048 lds
  buffer_load_dwordx4 v115, s[8:11], s54 offen offset:3072 lds
  s_add_u32 m0, s51, 0
  s_nop 0
  buffer_load_dwordx4 v116, s[12:15], s55 offen lds
  buffer_load_dwordx4 v117, s[12:15], s55 offen offset:1024 lds
  buffer_load_dwordx4 v118, s[12:15], s55 offen offset:2048 lds
  s_add_u32 m0, s52, 0
  s_nop 0
  buffer_load_dwordx4 v119, s[16:19], s54 offen lds
  s_add_u32 m0, s53, 0
  s_mov_b32 exec_hi, 0
  buffer_load_dwordx4 v120, s[16:19], s54 offen lds
  s_mov_b32 exec_hi, -1
  s_waitcnt vmcnt(18)
  s_barrier
  s_add_u32 s63, s62, 9
  s_cmp_ge_u32 s63, 10
  s_cselect_b32 s54, 10, 0
  s_sub_u32 s63, s63, s54
  s_lshl_b32 s54, s63, 7
  s_mul_i32 s55, s63, 196608
  s_add_u32 m0, s50, 16384
  s_nop 0
  buffer_load_dwordx4 v112, s[8:11], s54 offen lds
  buffer_load_dwordx4 v113, s[8:11], s54 offen offset:1024 lds
  buffer_load_dwordx4 v114, s[8:11], s54 offen offset:2048 lds
  buffer_load_dwordx4 v115, s[8:11], s54 offen offset:3072 lds
  s_add_u32 m0, s51, 12288
  s_nop 0
  buffer_load_dwordx4 v116, s[12:15], s55 offen lds
  buffer_load_dwordx4 v117, s[12:15], s55 offen offset:1024 lds
  buffer_load_dwordx4 v118, s[12:15], s55 offen offset:2048 lds
  s_add_u32 m0, s52, 6144
  s_nop 0
  buffer_load_dwordx4 v119, s[16:19], s54 offen lds
  s_add_u32 m0, s53, 6144
  s_mov_b32 exec_hi, 0
  buffer_load_dwordx4 v120, s[16:19], s54 offen lds
  s_mov_b32 exec_hi, -1
  s_waitcnt vmcnt(18)
  s_barrier
  s_mov_b32 m0, s56
  s_nop 0
  buffer_load_dwordx4 v125, s[20:23], 0 offen lds
  buffer_load_dwordx4 v125, s[20:23], s57 offen offset:1024 lds
  s_waitcnt vmcnt(11)
  s_barrier
  s_waitcnt vmcnt(2)
  s_barrier
  s_waitcnt vmcnt(0)
  ds_read_b64_tr_b16 v[128:129], v8 offset:0
  ds_read_b64_tr_b16 v[130:131], v8 offset:1024
  ds_read_b64_tr_b16 v[132:133], v8 offset:32
  ds_read_b64_tr_b16 v[134:135], v8 offset:1056
  s_waitcnt lgkmcnt(0)
  buffer_store_dwordx4 v[128:131], v9, s[24:27], s40 offen sc1
  buffer_store_dwordx4 v[132:135], v9, s[24:27], s41 offen sc1
L1_END:
  s_endpgm

.globl fnet_l2_kernel
.p2align 8
.type fnet_l2_kernel,@function
fnet_l2_kernel:
  s_cmp_ge_u32 s2, 256
  s_cbranch_scc1 L2_END
  s_load_dwordx2 s[28:29], s[0:1], 0
  s_load_dwordx2 s[30:31], s[0:1], 64
  s_load_dwordx2 s[32:33], s[0:1], 80
  v_lshrrev_b32 v2, 6, v0
  v_and_b32 v1, 63, v0
  v_readfirstlane_b32 s3, v2
  s_and_b32 s40, s2, 7
  s_lshr_b32 s41, s2, 3
  s_lshr_b32 s43, s40, 1
  s_and_b32 s42, s41, 7
  s_lshl_b32 s44, s43, 2
  s_add_u32 s4, s44, s42
  s_add_u32 s4, s4, 1
  s_cmp_eq_u32 s4, 16
  s_cselect_b32 s4, 0, s4
  s_sub_u32 s45, 24, s44
  s_add_u32 s45, s45, s42
  s_cmp_ge_u32 s42, 4
  s_cselect_b32 s4, s45, s4
  s_lshr_b32 s42, s41, 3
  s_and_b32 s43, s40, 1
  s_add_u32 s44, s42, 4
  s_cmp_lt_u32 s42, 2
  s_cselect_b32 s44, s42, s44
  s_add_u32 s45, s42, 2
  s_cmp_eq_u32 s43, 1
  s_cselect_b32 s5, s45, s44
  s_lshr_b32 s6, s3, 1
  s_and_b32 s7, s3, 1
  v_and_b32 v2, 15, v1
  v_lshrrev_b32 v3, 4, v1
  v_lshlrev_b32 v4, 4, v1
  s_mul_i32 s35, s5, 80
  s_sub_u32 s40, 640, s35
  s_sub_u32 s41, 32, s4
  s_and_b32 s41, s41, 31
  s_cmp_eq_u32 s4, 0
  s_cselect_b32 s42, 64, 63
  s_cmp_ge_u32 s5, 4
  s_cselect_b32 s34, -1, 1
  s_cselect_b32 s35, s40, s35
  s_cselect_b32 s36, s41, s4
  s_cselect_b32 s37, s42, 0
  v_mul_lo_u32 v5, v2, s34
  v_mul_u32_u24 v6, 5120, v3
  s_lshl_b32 s40, s34, 4
  s_mov_b32 s41, s35
  v_add_u32 v7, s41, v5
  v_cmp_ne_u32 vcc, 320, v7
  s_nop 1
  v_cndmask_b32 v7, 0, v7, vcc
  v_lshl_add_u32 v8, v7, 4, v6
  s_add_u32 s41, s41, s40
  v_add_u32 v7, s41, v5
  v_lshl_add_u32 v9, v7, 4, v6
  s_add_u32 s41, s41, s40
  v_add_u32 v7, s41, v5
  v_lshl_add_u32 v10, v7, 4, v6
  s_add_u32 s41, s41, s40
  v_add_u32 v7, s41, v5
  v_lshl_add_u32 v11, v7, 4, v6
  s_add_u32 s41, s41, s40
  v_add_u32 v7, s41, v5
  v_lshl_add_u32 v12, v7, 4, v6
  s_lshl_b32 s38, s36, 4
  s_lshl_b32 s40, s3, 2
  s_add_u32 s38, s38, s40
  s_mul_i32 s38, s38, 5120
  s_add_u32 s38, s38, 0x600000
  s_mul_i32 s40, s5, 5
  s_add_u32 s41, s40, s3
  s_mul_i32 s20, s41, 49152
  s_add_u32 s20, s20, 0x880000
  s_add_u32 s41, s40, 4
  s_mul_i32 s21, s41, 49152
  s_lshl_b32 s41, s3, 10
  s_add_u32 s21, s21, s41
  s_add_u32 s21, s21, 0x880000
  s_lshl_b32 s40, s6, 5
  s_add_u32 s40, s40, s4
  s_lshl_b32 s40, s40, 1
  s_add_u32 s40, s40, s7
  s_mul_i32 s22, s40, 49152
  s_lshl_b32 s23, s3, 12
  s_lshl_b32 s24, s3, 10
  s_add_u32 s24, s24, 16384
  s_mov_b32 s25, 0
  s_and_b32 s25, s2, 1
  s_mul_i32 s25, s25, 24576
  s_mov_b32 s26, s25
  s_waitcnt lgkmcnt(0)
  s_mov_b32 s8, s32
  s_mov_b32 s9, s33
  s_mov_b32 s10, 0xa60000
  s_mov_b32 s11, 0x00020000
  s_mov_b32 s12, s28
  s_mov_b32 s13, s29
  s_mov_b32 s14, 0x280000
  s_mov_b32 s15, 0x00020000
  s_mov_b32 s16, s30
  s_mov_b32 s17, s31
  s_mov_b32 s18, 0x280000
  s_mov_b32 s19, 0x00020000
  s_lshl_b32 s39, s3, 10
  s_add_u32 s39, s39, 122880
  s_add_u32 s40, s20, s25
  s_add_u32 m0, s23, 0
  s_add_u32 s41, s21, s25
  buffer_load_dwordx4 v4, s[8:11], s40 offen offset:0 lds
  buffer_load_dwordx4 v4, s[8:11], s40 offen offset:1024 lds
  buffer_load_dwordx4 v4, s[8:11], s40 offen offset:2048 lds
  buffer_load_dwordx4 v4, s[8:11], s40 offen offset:3072 lds
  s_add_u32 m0, s24, 0
  s_add_u32 s25, s25, 4096
  buffer_load_dwordx4 v4, s[8:11], s41 offen lds
  s_cmp_eq_u32 s25, 49152
  s_cselect_b32 s25, 0, s25
  s_add_u32 s42, s22, s26
  s_add_u32 s26, s26, 4096
  buffer_load_dwordx4 a[0:3], v4, s[8:11], s42 offen offset:0
  buffer_load_dwordx4 a[4:7], v4, s[8:11], s42 offen offset:1024
  buffer_load_dwordx4 a[8:11], v4, s[8:11], s42 offen offset:2048
  buffer_load_dwordx4 a[12:15], v4, s[8:11], s42 offen offset:3072
  s_cmp_eq_u32 s26, 49152
  s_cselect_b32 s26, 0, s26
  s_lshl_b32 s40, s7, 5
  s_add_u32 s40, s40, s6
  v_lshlrev_b32 v5, 1, v2
  v_add_u32 v5, s40, v5
  v_mul_lo_u32 v5, v5, s34
  v_add_u32 v5, s37, v5
  v_and_b32 v5, 63, v5
  v_cvt_f32_u32 v5, v5
  v_mul_f32 v5, 0x3c800000, v5
  v_lshlrev_b32 v6, 2, v3
  v_cvt_f32_u32 v6, v6
  v_add_f32 v7, 0x0, v6
  v_mul_f32 v7, v7, v5
  v_cos_f32 v176, v7
  v_sin_f32 v180, v7
  v_add_f32 v7, 0x3f800000, v6
  v_mul_f32 v7, v7, v5
  v_cos_f32 v177, v7
  v_sin_f32 v181, v7
  v_add_f32 v7, 0x40000000, v6
  v_mul_f32 v7, v7, v5
  v_cos_f32 v178, v7
  v_sin_f32 v182, v7
  v_add_f32 v7, 0x40400000, v6
  v_mul_f32 v7, v7, v5
  v_cos_f32 v179, v7
  v_sin_f32 v183, v7
  s_nop 0
  v_cvt_pk_bf16_f32 v136, v176, -v180
  v_cvt_pk_bf16_f32 v137, v177, -v181
  v_cvt_pk_bf16_f32 v138, v178, -v182
  v_cvt_pk_bf16_f32 v139, v179, -v183
  v_add_f32 v7, 0x41800000, v6
  v_mul_f32 v7, v7, v5
  v_cos_f32 v176, v7
  v_sin_f32 v180, v7
  v_add_f32 v7, 0x41880000, v6
  v_mul_f32 v7, v7, v5
  v_cos_f32 v177, v7
  v_sin_f32 v181, v7
  v_add_f32 v7, 0x41900000, v6
  v_mul_f32 v7, v7, v5
  v_cos_f32 v178, v7
  v_sin_f32 v182, v7
  v_add_f32 v7, 0x41980000, v6
  v_mul_f32 v7, v7, v5
  v_cos_f32 v179, v7
  v_sin_f32 v183, v7
  s_nop 0
  v_cvt_pk_bf16_f32 v140, v176, -v180
  v_cvt_pk_bf16_f32 v141, v177, -v181
  v_cvt_pk_bf16_f32 v142, v178, -v182
  v_cvt_pk_bf16_f32 v143, v179, -v183
  s_add_u32 s40, s20, s25
  s_add_u32 m0, s23, 20480
  s_add_u32 s41, s21, s25
  buffer_load_dwordx4 v4, s[8:11], s40 offen offset:0 lds
  buffer_load_dwordx4 v4, s[8:11], s40 offen offset:1024 lds
  buffer_load_dwordx4 v4, s[8:11], s40 offen offset:2048 lds
  buffer_load_dwordx4 v4, s[8:11], s40 offen offset:3072 lds
  s_add_u32 m0, s24, 20480
  s_add_u32 s25, s25, 4096
  buffer_load_dwordx4 v4, s[8:11], s41 offen lds
  s_cmp_eq_u32 s25, 49152
  s_cselect_b32 s25, 0, s25
  s_add_u32 s42, s22, s26
  s_add_u32 s26, s26, 4096
  buffer_load_dwordx4 a[16:19], v4, s[8:11], s42 offen offset:0
  buffer_load_dwordx4 a[20:23], v4, s[8:11], s42 offen offset:1024
  buffer_load_dwordx4 a[24:27], v4, s[8:11], s42 offen offset:2048
  buffer_load_dwordx4 a[28:31], v4, s[8:11], s42 offen offset:3072
  s_cmp_eq_u32 s26, 49152
  s_cselect_b32 s26, 0, s26
  s_add_u32 m0, s39, 0
  s_nop 0
  buffer_load_dwordx4 v8, s[8:11], s38 offen lds
  s_add_u32 m0, s39, 4096
  s_nop 0
  buffer_load_dwordx4 v9, s[8:11], s38 offen lds
  s_add_u32 m0, s39, 8192
  s_nop 0
  buffer_load_dwordx4 v10, s[8:11], s38 offen lds
  v_add_f32 v7, 0x42000000, v6
  v_mul_f32 v7, v7, v5
  v_cos_f32 v176, v7
  v_sin_f32 v180, v7
  v_add_f32 v7, 0x42040000, v6
  v_mul_f32 v7, v7, v5
  v_cos_f32 v177, v7
  v_sin_f32 v181, v7
  v_add_f32 v7, 0x42080000, v6
  v_mul_f32 v7, v7, v5
  v_cos_f32 v178, v7
  v_sin_f32 v182, v7
  v_add_f32 v7, 0x420c0000, v6
  v_mul_f32 v7, v7, v5
  v_cos_f32 v179, v7
  v_sin_f32 v183, v7
  s_nop 0
  v_cvt_pk_bf16_f32 v144, v176, -v180
  v_cvt_pk_bf16_f32 v145, v177, -v181
  v_cvt_pk_bf16_f32 v146, v178, -v182
  v_cvt_pk_bf16_f32 v147, v179, -v183
  v_add_f32 v7, 0x42400000, v6
  v_mul_f32 v7, v7, v5
  v_cos_f32 v176, v7
  v_sin_f32 v180, v7
  v_add_f32 v7, 0x42440000, v6
  v_mul_f32 v7, v7, v5
  v_cos_f32 v177, v7
  v_sin_f32 v181, v7
  v_add_f32 v7, 0x42480000, v6
  v_mul_f32 v7, v7, v5
  v_cos_f32 v178, v7
  v_sin_f32 v182, v7
  v_add_f32 v7, 0x424c0000, v6
  v_mul_f32 v7, v7, v5
  v_cos_f32 v179, v7
  v_sin_f32 v183, v7
  s_nop 0
  v_cvt_pk_bf16_f32 v148, v176, -v180
  v_cvt_pk_bf16_f32 v149, v177, -v181
  v_cvt_pk_bf16_f32 v150, v178, -v182
  v_cvt_pk_bf16_f32 v151, v179, -v183
  v_mov_b32 v16, 0
  v_mov_b32 v17, 0
  v_mov_b32 v18, 0
  v_mov_b32 v19, 0
  v_mov_b32 v20, 0
  v_mov_b32 v21, 0
  v_mov_b32 v22, 0
  v_mov_b32 v23, 0
  v_mov_b32 v24, 0
  v_mov_b32 v25, 0
  v_mov_b32 v26, 0
  v_mov_b32 v27, 0
  v_mov_b32 v28, 0
  v_mov_b32 v29, 0
  v_mov_b32 v30, 0
  v_mov_b32 v31, 0
  v_mov_b32 v32, 0
  v_mov_b32 v33, 0
  v_mov_b32 v34, 0
  v_mov_b32 v35, 0
  v_mov_b32 v36, 0
  v_mov_b32 v37, 0
  v_mov_b32 v38, 0
  v_mov_b32 v39, 0
  v_mov_b32 v40, 0
  v_mov_b32 v41, 0
  v_mov_b32 v42, 0
  v_mov_b32 v43, 0
  v_mov_b32 v44, 0
  v_mov_b32 v45, 0
  v_mov_b32 v46, 0
  v_mov_b32 v47, 0
  v_mov_b32 v48, 0
  v_mov_b32 v49, 0
  v_mov_b32 v50, 0
  v_mov_b32 v51, 0
  v_mov_b32 v52, 0
  v_mov_b32 v53, 0
  v_mov_b32 v54, 0
  v_mov_b32 v55, 0
  v_mov_b32 v14, v4
  v_add_u32 v15, 61440, v4
  v_add_u32 v13, 122880, v4
  s_waitcnt vmcnt(12)
  s_barrier
  ds_read_b128 v[56:59], v14 offset:0
  ds_read_b128 v[60:63], v14 offset:4096
  ds_read_b128 v[64:67], v14 offset:8192
  ds_read_b128 v[68:71], v14 offset:12288
  ds_read_b128 v[72:75], v14 offset:16384
  ds_read_b128 v[76:79], v14 offset:1024
  ds_read_b128 v[80:83], v14 offset:5120
  ds_read_b128 v[84:87], v14 offset:9216
  ds_read_b128 v[88:91], v14 offset:13312
  ds_read_b128 v[92:95], v14 offset:17408
  s_add_u32 m0, s39, 12288
  s_nop 0
  buffer_load_dwordx4 v11, s[8:11], s38 offen lds
  s_add_u32 m0, s39, 16384
  s_nop 0
  buffer_load_dwordx4 v12, s[8:11], s38 offen lds
  s_add_u32 s40, s20, s25
  s_add_u32 m0, s23, 40960
  s_add_u32 s41, s21, s25
  buffer_load_dwordx4 v4, s[8:11], s40 offen offset:0 lds
  buffer_load_dwordx4 v4, s[8:11], s40 offen offset:1024 lds
  buffer_load_dwordx4 v4, s[8:11], s40 offen offset:2048 lds
  s_waitcnt lgkmcnt(0)
  v_mfma_f32_16x16x32_bf16 v[16:19], v[56:59], a[0:3], v[16:19]
  ds_read_b128 v[96:99], v14 offset:2048
  ds_read_b128 v[100:103], v14 offset:6144
  v_mfma_f32_16x16x32_bf16 v[20:23], v[60:63], a[0:3], v[20:23]
  ds_read_b128 v[104:107], v14 offset:10240
  ds_read_b128 v[108:111], v14 offset:14336
  v_mfma_f32_16x16x32_bf16 v[24:27], v[64:67], a[0:3], v[24:27]
  ds_read_b128 v[112:115], v14 offset:18432
  ds_read_b128 v[116:119], v14 offset:3072
  v_mfma_f32_16x16x32_bf16 v[28:31], v[68:71], a[0:3], v[28:31]
  ds_read_b128 v[120:123], v14 offset:7168
  ds_read_b128 v[124:127], v14 offset:11264
  v_mfma_f32_16x16x32_bf16 v[32:35], v[72:75], a[0:3], v[32:35]
  ds_read_b128 v[128:131], v14 offset:15360
  ds_read_b128 v[132:135], v14 offset:19456
  v_mfma_f32_16x16x32_bf16 v[16:19], v[76:79], a[4:7], v[16:19]
  buffer_load_dwordx4 v4, s[8:11], s40 offen offset:3072 lds
  s_add_u32 m0, s24, 40960
  s_add_u32 s25, s25, 4096
  buffer_load_dwordx4 v4, s[8:11], s41 offen lds
  v_mfma_f32_16x16x32_bf16 v[20:23], v[80:83], a[4:7], v[20:23]
  s_cmp_eq_u32 s25, 49152
  s_cselect_b32 s25, 0, s25
  s_add_u32 s42, s22, s26
  s_add_u32 s26, s26, 4096
  v_mfma_f32_16x16x32_bf16 v[24:27], v[84:87], a[4:7], v[24:27]
  buffer_load_dwordx4 a[32:35], v4, s[8:11], s42 offen offset:0
  buffer_load_dwordx4 a[36:39], v4, s[8:11], s42 offen offset:1024
  v_mfma_f32_16x16x32_bf16 v[28:31], v[88:91], a[4:7], v[28:31]
  buffer_load_dwordx4 a[40:43], v4, s[8:11], s42 offen offset:2048
  v_mfma_f32_16x16x32_bf16 v[32:35], v[92:95], a[4:7], v[32:35]
  s_waitcnt lgkmcnt(0)
  s_waitcnt vmcnt(13)
  s_barrier
  v_mfma_f32_16x16x32_bf16 v[16:19], v[96:99], a[8:11], v[16:19]
  ds_read_b128 v[56:59], v14 offset:20480
  ds_read_b128 v[60:63], v14 offset:24576
  v_mfma_f32_16x16x32_bf16 v[20:23], v[100:103], a[8:11], v[20:23]
  ds_read_b128 v[64:67], v14 offset:28672
  ds_read_b128 v[68:71], v14 offset:32768
  v_mfma_f32_16x16x32_bf16 v[24:27], v[104:107], a[8:11], v[24:27]
  ds_read_b128 v[72:75], v14 offset:36864
  ds_read_b128 v[76:79], v14 offset:21504
  v_mfma_f32_16x16x32_bf16 v[28:31], v[108:111], a[8:11], v[28:31]
  ds_read_b128 v[80:83], v14 offset:25600
  ds_read_b128 v[84:87], v14 offset:29696
  v_mfma_f32_16x16x32_bf16 v[32:35], v[112:115], a[8:11], v[32:35]
  ds_read_b128 v[88:91], v14 offset:33792
  ds_read_b128 v[92:95], v14 offset:37888
  v_mfma_f32_16x16x32_bf16 v[16:19], v[116:119], a[12:15], v[16:19]
  buffer_load_dwordx4 a[44:47], v4, s[8:11], s42 offen offset:3072
  s_cmp_eq_u32 s26, 49152
  s_cselect_b32 s26, 0, s26
  v_mfma_f32_16x16x32_bf16 v[20:23], v[120:123], a[12:15], v[20:23]
  s_add_u32 s40, s20, s25
  s_add_u32 m0, s23, 61440
  s_add_u32 s41, s21, s25
  buffer_load_dwordx4 v4, s[8:11], s40 offen offset:0 lds
  v_mfma_f32_16x16x32_bf16 v[24:27], v[124:127], a[12:15], v[24:27]
  buffer_load_dwordx4 v4, s[8:11], s40 offen offset:1024 lds
  buffer_load_dwordx4 v4, s[8:11], s40 offen offset:2048 lds
  v_mfma_f32_16x16x32_bf16 v[28:31], v[128:131], a[12:15], v[28:31]
  buffer_load_dwordx4 v4, s[8:11], s40 offen offset:3072 lds
  v_mfma_f32_16x16x32_bf16 v[32:35], v[132:135], a[12:15], v[32:35]
  s_waitcnt lgkmcnt(0)
  v_mfma_f32_16x16x32_bf16 v[16:19], v[56:59], a[16:19], v[16:19]
  ds_read_b128 v[96:99], v14 offset:22528
  ds_read_b128 v[100:103], v14 offset:26624
  v_mfma_f32_16x16x32_bf16 v[20:23], v[60:63], a[16:19], v[20:23]
  ds_read_b128 v[104:107], v14 offset:30720
  ds_read_b128 v[108:111], v14 offset:34816
  v_mfma_f32_16x16x32_bf16 v[24:27], v[64:67], a[16:19], v[24:27]
  ds_read_b128 v[112:115], v14 offset:38912
  ds_read_b128 v[116:119], v14 offset:23552
  v_mfma_f32_16x16x32_bf16 v[28:31], v[68:71], a[16:19], v[28:31]
  ds_read_b128 v[120:123], v14 offset:27648
  ds_read_b128 v[124:127], v14 offset:31744
  v_mfma_f32_16x16x32_bf16 v[32:35], v[72:75], a[16:19], v[32:35]
  ds_read_b128 v[128:131], v14 offset:35840
  ds_read_b128 v[132:135], v14 offset:39936
  v_mfma_f32_16x16x32_bf16 v[16:19], v[76:79], a[20:23], v[16:19]
  s_add_u32 m0, s24, 61440
  s_add_u32 s25, s25, 4096
  buffer_load_dwordx4 v4, s[8:11], s41 offen lds
  s_cmp_eq_u32 s25, 49152
  s_cselect_b32 s25, 0, s25
  v_mfma_f32_16x16x32_bf16 v[20:23], v[80:83], a[20:23], v[20:23]
  s_add_u32 s42, s22, s26
  s_add_u32 s26, s26, 4096
  buffer_load_dwordx4 a[48:51], v4, s[8:11], s42 offen offset:0
  v_mfma_f32_16x16x32_bf16 v[24:27], v[84:87], a[20:23], v[24:27]
  buffer_load_dwordx4 a[52:55], v4, s[8:11], s42 offen offset:1024
  buffer_load_dwordx4 a[56:59], v4, s[8:11], s42 offen offset:2048
  v_mfma_f32_16x16x32_bf16 v[28:31], v[88:91], a[20:23], v[28:31]
  buffer_load_dwordx4 a[60:63], v4, s[8:11], s42 offen offset:3072
  s_cmp_eq_u32 s26, 49152
  s_cselect_b32 s26, 0, s26
  v_mfma_f32_16x16x32_bf16 v[32:35], v[92:95], a[20:23], v[32:35]
  s_add_u32 s40, s20, s25
  s_add_u32 m0, s23, 81920
  s_add_u32 s41, s21, s25
  s_waitcnt lgkmcnt(0)
  s_waitcnt vmcnt(9)
  s_barrier
  v_mfma_f32_16x16x32_bf16 v[16:19], v[96:99], a[24:27], v[16:19]
  ds_read_b128 v[56:59], v14 offset:40960
  ds_read_b128 v[60:63], v14 offset:45056
  v_mfma_f32_16x16x32_bf16 v[20:23], v[100:103], a[24:27], v[20:23]
  ds_read_b128 v[64:67], v14 offset:49152
  ds_read_b128 v[68:71], v14 offset:53248
  v_mfma_f32_16x16x32_bf16 v[24:27], v[104:107], a[24:27], v[24:27]
  ds_read_b128 v[72:75], v14 offset:57344
  ds_read_b128 v[76:79], v14 offset:41984
  v_mfma_f32_16x16x32_bf16 v[28:31], v[108:111], a[24:27], v[28:31]
  ds_read_b128 v[80:83], v14 offset:46080
  ds_read_b128 v[84:87], v14 offset:50176
  v_mfma_f32_16x16x32_bf16 v[32:35], v[112:115], a[24:27], v[32:35]
  ds_read_b128 v[88:91], v14 offset:54272
  ds_read_b128 v[92:95], v14 offset:58368
  v_mfma_f32_16x16x32_bf16 v[16:19], v[116:119], a[28:31], v[16:19]
  buffer_load_dwordx4 v4, s[8:11], s40 offen offset:0 lds
  buffer_load_dwordx4 v4, s[8:11], s40 offen offset:1024 lds
  v_mfma_f32_16x16x32_bf16 v[20:23], v[120:123], a[28:31], v[20:23]
  buffer_load_dwordx4 v4, s[8:11], s40 offen offset:2048 lds
  buffer_load_dwordx4 v4, s[8:11], s40 offen offset:3072 lds
  v_mfma_f32_16x16x32_bf16 v[24:27], v[124:127], a[28:31], v[24:27]
  s_add_u32 m0, s24, 81920
  s_add_u32 s25, s25, 4096
  buffer_load_dwordx4 v4, s[8:11], s41 offen lds
  s_cmp_eq_u32 s25, 49152
  s_cselect_b32 s25, 0, s25
  v_mfma_f32_16x16x32_bf16 v[28:31], v[128:131], a[28:31], v[28:31]
  s_add_u32 s42, s22, s26
  s_add_u32 s26, s26, 4096
  v_mfma_f32_16x16x32_bf16 v[32:35], v[132:135], a[28:31], v[32:35]
  s_waitcnt lgkmcnt(0)
  ds_read_b128 v[96:99], v13 offset:0
  ds_read_b128 v[100:103], v13 offset:4096
  ds_read_b128 v[104:107], v13 offset:8192
  ds_read_b128 v[108:111], v13 offset:12288
  ds_read_b128 v[112:115], v13 offset:16384
  ds_read_b128 v[116:119], v13 offset:1024
  ds_read_b128 v[120:123], v13 offset:5120
  ds_read_b128 v[124:127], v13 offset:9216
  ds_read_b128 v[128:131], v13 offset:13312
  ds_read_b128 v[132:135], v13 offset:17408
  ds_read_b128 v[216:219], v13 offset:2048
  ds_read_b128 v[220:223], v13 offset:6144
  ds_read_b128 v[224:227], v13 offset:10240
  ds_read_b128 v[228:231], v13 offset:14336
  ds_read_b128 v[232:235], v13 offset:18432
  ds_read_b128 v[236:239], v13 offset:3072
  ds_read_b128 v[240:243], v13 offset:7168
  ds_read_b128 v[244:247], v13 offset:11264
  ds_read_b128 v[248:251], v13 offset:15360
  ds_read_b128 v[252:255], v13 offset:19456
  buffer_load_dwordx4 a[64:67], v4, s[8:11], s42 offen offset:0
  buffer_load_dwordx4 a[68:71], v4, s[8:11], s42 offen offset:1024
  s_waitcnt lgkmcnt(10)
  v_mfma_f32_16x16x32_bf16 v[36:39], v[96:99], v[136:139], v[36:39]
  buffer_load_dwordx4 a[72:75], v4, s[8:11], s42 offen offset:2048
  buffer_load_dwordx4 a[76:79], v4, s[8:11], s42 offen offset:3072
  v_mfma_f32_16x16x32_bf16 v[40:43], v[100:103], v[136:139], v[40:43]
  s_cmp_eq_u32 s26, 49152
  s_cselect_b32 s26, 0, s26
  s_add_u32 s40, s20, s25
  s_add_u32 m0, s23, 102400
  s_add_u32 s41, s21, s25
  v_mfma_f32_16x16x32_bf16 v[44:47], v[104:107], v[136:139], v[44:47]
  v_mfma_f32_16x16x32_bf16 v[48:51], v[108:111], v[136:139], v[48:51]
  v_mfma_f32_16x16x32_bf16 v[52:55], v[112:115], v[136:139], v[52:55]
  v_mfma_f32_16x16x32_bf16 v[36:39], v[116:119], v[140:143], v[36:39]
  v_mfma_f32_16x16x32_bf16 v[40:43], v[120:123], v[140:143], v[40:43]
  v_mfma_f32_16x16x32_bf16 v[44:47], v[124:127], v[140:143], v[44:47]
  v_mfma_f32_16x16x32_bf16 v[48:51], v[128:131], v[140:143], v[48:51]
  v_mfma_f32_16x16x32_bf16 v[52:55], v[132:135], v[140:143], v[52:55]
  s_waitcnt lgkmcnt(0)
  v_mfma_f32_16x16x32_bf16 v[36:39], v[216:219], v[144:147], v[36:39]
  buffer_load_dwordx4 v4, s[8:11], s40 offen offset:0 lds
  buffer_load_dwordx4 v4, s[8:11], s40 offen offset:1024 lds
  v_mfma_f32_16x16x32_bf16 v[40:43], v[220:223], v[144:147], v[40:43]
  v_mfma_f32_16x16x32_bf16 v[44:47], v[224:227], v[144:147], v[44:47]
  v_mfma_f32_16x16x32_bf16 v[48:51], v[228:231], v[144:147], v[48:51]
  v_mfma_f32_16x16x32_bf16 v[52:55], v[232:235], v[144:147], v[52:55]
  v_mfma_f32_16x16x32_bf16 v[36:39], v[236:239], v[148:151], v[36:39]
  v_mfma_f32_16x16x32_bf16 v[40:43], v[240:243], v[148:151], v[40:43]
  v_mfma_f32_16x16x32_bf16 v[44:47], v[244:247], v[148:151], v[44:47]
  v_mfma_f32_16x16x32_bf16 v[48:51], v[248:251], v[148:151], v[48:51]
  v_mfma_f32_16x16x32_bf16 v[52:55], v[252:255], v[148:151], v[52:55]
  v_mfma_f32_16x16x32_bf16 v[16:19], v[56:59], a[32:35], v[16:19]
  ds_read_b128 v[96:99], v14 offset:43008
  ds_read_b128 v[100:103], v14 offset:47104
  v_mfma_f32_16x16x32_bf16 v[20:23], v[60:63], a[32:35], v[20:23]
  ds_read_b128 v[104:107], v14 offset:51200
  ds_read_b128 v[108:111], v14 offset:55296
  v_mfma_f32_16x16x32_bf16 v[24:27], v[64:67], a[32:35], v[24:27]
  ds_read_b128 v[112:115], v14 offset:59392
  ds_read_b128 v[116:119], v14 offset:44032
  v_mfma_f32_16x16x32_bf16 v[28:31], v[68:71], a[32:35], v[28:31]
  ds_read_b128 v[120:123], v14 offset:48128
  ds_read_b128 v[124:127], v14 offset:52224
  v_mfma_f32_16x16x32_bf16 v[32:35], v[72:75], a[32:35], v[32:35]
  ds_read_b128 v[128:131], v14 offset:56320
  ds_read_b128 v[132:135], v14 offset:60416
  v_mfma_f32_16x16x32_bf16 v[16:19], v[76:79], a[36:39], v[16:19]
  buffer_load_dwordx4 v4, s[8:11], s40 offen offset:2048 lds
  buffer_load_dwordx4 v4, s[8:11], s40 offen offset:3072 lds
  v_mfma_f32_16x16x32_bf16 v[20:23], v[80:83], a[36:39], v[20:23]
  s_add_u32 m0, s24, 102400
  s_add_u32 s25, s25, 4096
  buffer_load_dwordx4 v4, s[8:11], s41 offen lds
  s_cmp_eq_u32 s25, 49152
  s_cselect_b32 s25, 0, s25
  v_mfma_f32_16x16x32_bf16 v[24:27], v[84:87], a[36:39], v[24:27]
  s_add_u32 s42, s22, s26
  s_add_u32 s26, s26, 4096
  buffer_load_dwordx4 a[80:83], v4, s[8:11], s42 offen offset:0
  v_mfma_f32_16x16x32_bf16 v[28:31], v[88:91], a[36:39], v[28:31]
  buffer_load_dwordx4 a[84:87], v4, s[8:11], s42 offen offset:1024
  v_mfma_f32_16x16x32_bf16 v[32:35], v[92:95], a[36:39], v[32:35]
  s_waitcnt lgkmcnt(0)
  s_waitcnt vmcnt(16)
  s_barrier
  v_mfma_f32_16x16x32_bf16 v[16:19], v[96:99], a[40:43], v[16:19]
  ds_read_b128 v[56:59], v15 offset:0
  ds_read_b128 v[60:63], v15 offset:4096
  v_mfma_f32_16x16x32_bf16 v[20:23], v[100:103], a[40:43], v[20:23]
  ds_read_b128 v[64:67], v15 offset:8192
  ds_read_b128 v[68:71], v15 offset:12288
  v_mfma_f32_16x16x32_bf16 v[24:27], v[104:107], a[40:43], v[24:27]
  ds_read_b128 v[72:75], v15 offset:16384
  ds_read_b128 v[76:79], v15 offset:1024
  v_mfma_f32_16x16x32_bf16 v[28:31], v[108:111], a[40:43], v[28:31]
  ds_read_b128 v[80:83], v15 offset:5120
  ds_read_b128 v[84:87], v15 offset:9216
  v_mfma_f32_16x16x32_bf16 v[32:35], v[112:115], a[40:43], v[32:35]
  ds_read_b128 v[88:91], v15 offset:13312
  ds_read_b128 v[92:95], v15 offset:17408
  v_mfma_f32_16x16x32_bf16 v[16:19], v[116:119], a[44:47], v[16:19]
  buffer_load_dwordx4 a[88:91], v4, s[8:11], s42 offen offset:2048
  buffer_load_dwordx4 a[92:95], v4, s[8:11], s42 offen offset:3072
  v_mfma_f32_16x16x32_bf16 v[20:23], v[120:123], a[44:47], v[20:23]
  s_cmp_eq_u32 s26, 49152
  s_cselect_b32 s26, 0, s26
  s_add_u32 s40, s20, s25
  s_add_u32 m0, s23, 0
  s_add_u32 s41, s21, s25
  v_mfma_f32_16x16x32_bf16 v[24:27], v[124:127], a[44:47], v[24:27]
  buffer_load_dwordx4 v4, s[8:11], s40 offen offset:0 lds
  buffer_load_dwordx4 v4, s[8:11], s40 offen offset:1024 lds
  v_mfma_f32_16x16x32_bf16 v[28:31], v[128:131], a[44:47], v[28:31]
  buffer_load_dwordx4 v4, s[8:11], s40 offen offset:2048 lds
  v_mfma_f32_16x16x32_bf16 v[32:35], v[132:135], a[44:47], v[32:35]
  s_waitcnt lgkmcnt(0)
  v_mfma_f32_16x16x32_bf16 v[16:19], v[56:59], a[48:51], v[16:19]
  ds_read_b128 v[96:99], v15 offset:2048
  ds_read_b128 v[100:103], v15 offset:6144
  v_mfma_f32_16x16x32_bf16 v[20:23], v[60:63], a[48:51], v[20:23]
  ds_read_b128 v[104:107], v15 offset:10240
  ds_read_b128 v[108:111], v15 offset:14336
  v_mfma_f32_16x16x32_bf16 v[24:27], v[64:67], a[48:51], v[24:27]
  ds_read_b128 v[112:115], v15 offset:18432
  ds_read_b128 v[116:119], v15 offset:3072
  v_mfma_f32_16x16x32_bf16 v[28:31], v[68:71], a[48:51], v[28:31]
  ds_read_b128 v[120:123], v15 offset:7168
  ds_read_b128 v[124:127], v15 offset:11264
  v_mfma_f32_16x16x32_bf16 v[32:35], v[72:75], a[48:51], v[32:35]
  ds_read_b128 v[128:131], v15 offset:15360
  ds_read_b128 v[132:135], v15 offset:19456
  v_mfma_f32_16x16x32_bf16 v[16:19], v[76:79], a[52:55], v[16:19]
  buffer_load_dwordx4 v4, s[8:11], s40 offen offset:3072 lds
  s_add_u32 m0, s24, 0
  s_add_u32 s25, s25, 4096
  buffer_load_dwordx4 v4, s[8:11], s41 offen lds
  v_mfma_f32_16x16x32_bf16 v[20:23], v[80:83], a[52:55], v[20:23]
  s_cmp_eq_u32 s25, 49152
  s_cselect_b32 s25, 0, s25
  s_add_u32 s42, s22, s26
  s_add_u32 s26, s26, 4096
  v_mfma_f32_16x16x32_bf16 v[24:27], v[84:87], a[52:55], v[24:27]
  buffer_load_dwordx4 a[96:99], v4, s[8:11], s42 offen offset:0
  buffer_load_dwordx4 a[100:103], v4, s[8:11], s42 offen offset:1024
  v_mfma_f32_16x16x32_bf16 v[28:31], v[88:91], a[52:55], v[28:31]
  buffer_load_dwordx4 a[104:107], v4, s[8:11], s42 offen offset:2048
  v_mfma_f32_16x16x32_bf16 v[32:35], v[92:95], a[52:55], v[32:35]
  s_waitcnt lgkmcnt(0)
  s_waitcnt vmcnt(17)
  s_barrier
  v_mfma_f32_16x16x32_bf16 v[16:19], v[96:99], a[56:59], v[16:19]
  ds_read_b128 v[56:59], v15 offset:20480
  ds_read_b128 v[60:63], v15 offset:24576
  v_mfma_f32_16x16x32_bf16 v[20:23], v[100:103], a[56:59], v[20:23]
  ds_read_b128 v[64:67], v15 offset:28672
  ds_read_b128 v[68:71], v15 offset:32768
  v_mfma_f32_16x16x32_bf16 v[24:27], v[104:107], a[56:59], v[24:27]
  ds_read_b128 v[72:75], v15 offset:36864
  ds_read_b128 v[76:79], v15 offset:21504
  v_mfma_f32_16x16x32_bf16 v[28:31], v[108:111], a[56:59], v[28:31]
  ds_read_b128 v[80:83], v15 offset:25600
  ds_read_b128 v[84:87], v15 offset:29696
  v_mfma_f32_16x16x32_bf16 v[32:35], v[112:115], a[56:59], v[32:35]
  ds_read_b128 v[88:91], v15 offset:33792
  ds_read_b128 v[92:95], v15 offset:37888
  v_mfma_f32_16x16x32_bf16 v[16:19], v[116:119], a[60:63], v[16:19]
  buffer_load_dwordx4 a[108:111], v4, s[8:11], s42 offen offset:3072
  s_cmp_eq_u32 s26, 49152
  s_cselect_b32 s26, 0, s26
  v_mfma_f32_16x16x32_bf16 v[20:23], v[120:123], a[60:63], v[20:23]
  s_add_u32 s40, s20, s25
  s_add_u32 m0, s23, 20480
  s_add_u32 s41, s21, s25
  buffer_load_dwordx4 v4, s[8:11], s40 offen offset:0 lds
  v_mfma_f32_16x16x32_bf16 v[24:27], v[124:127], a[60:63], v[24:27]
  buffer_load_dwordx4 v4, s[8:11], s40 offen offset:1024 lds
  buffer_load_dwordx4 v4, s[8:11], s40 offen offset:2048 lds
  v_mfma_f32_16x16x32_bf16 v[28:31], v[128:131], a[60:63], v[28:31]
  buffer_load_dwordx4 v4, s[8:11], s40 offen offset:3072 lds
  v_mfma_f32_16x16x32_bf16 v[32:35], v[132:135], a[60:63], v[32:35]
  s_waitcnt lgkmcnt(0)
  v_mfma_f32_16x16x32_bf16 v[16:19], v[56:59], a[64:67], v[16:19]
  ds_read_b128 v[96:99], v15 offset:22528
  ds_read_b128 v[100:103], v15 offset:26624
  v_mfma_f32_16x16x32_bf16 v[20:23], v[60:63], a[64:67], v[20:23]
  ds_read_b128 v[104:107], v15 offset:30720
  ds_read_b128 v[108:111], v15 offset:34816
  v_mfma_f32_16x16x32_bf16 v[24:27], v[64:67], a[64:67], v[24:27]
  ds_read_b128 v[112:115], v15 offset:38912
  ds_read_b128 v[116:119], v15 offset:23552
  v_mfma_f32_16x16x32_bf16 v[28:31], v[68:71], a[64:67], v[28:31]
  ds_read_b128 v[120:123], v15 offset:27648
  ds_read_b128 v[124:127], v15 offset:31744
  v_mfma_f32_16x16x32_bf16 v[32:35], v[72:75], a[64:67], v[32:35]
  ds_read_b128 v[128:131], v15 offset:35840
  ds_read_b128 v[132:135], v15 offset:39936
  v_mfma_f32_16x16x32_bf16 v[16:19], v[76:79], a[68:71], v[16:19]
  s_add_u32 m0, s24, 20480
  s_add_u32 s25, s25, 4096
  buffer_load_dwordx4 v4, s[8:11], s41 offen lds
  s_cmp_eq_u32 s25, 49152
  s_cselect_b32 s25, 0, s25
  v_mfma_f32_16x16x32_bf16 v[20:23], v[80:83], a[68:71], v[20:23]
  s_add_u32 s42, s22, s26
  s_add_u32 s26, s26, 4096
  buffer_load_dwordx4 a[0:3], v4, s[8:11], s42 offen offset:0
  v_mfma_f32_16x16x32_bf16 v[24:27], v[84:87], a[68:71], v[24:27]
  buffer_load_dwordx4 a[4:7], v4, s[8:11], s42 offen offset:1024
  buffer_load_dwordx4 a[8:11], v4, s[8:11], s42 offen offset:2048
  v_mfma_f32_16x16x32_bf16 v[28:31], v[88:91], a[68:71], v[28:31]
  buffer_load_dwordx4 a[12:15], v4, s[8:11], s42 offen offset:3072
  s_cmp_eq_u32 s26, 49152
  s_cselect_b32 s26, 0, s26
  v_mfma_f32_16x16x32_bf16 v[32:35], v[92:95], a[68:71], v[32:35]
  s_add_u32 s40, s20, s25
  s_add_u32 m0, s23, 40960
  s_add_u32 s41, s21, s25
  s_waitcnt lgkmcnt(0)
  s_waitcnt vmcnt(18)
  s_barrier
  v_mfma_f32_16x16x32_bf16 v[16:19], v[96:99], a[72:75], v[16:19]
  ds_read_b128 v[56:59], v15 offset:40960
  ds_read_b128 v[60:63], v15 offset:45056
  v_mfma_f32_16x16x32_bf16 v[20:23], v[100:103], a[72:75], v[20:23]
  ds_read_b128 v[64:67], v15 offset:49152
  ds_read_b128 v[68:71], v15 offset:53248
  v_mfma_f32_16x16x32_bf16 v[24:27], v[104:107], a[72:75], v[24:27]
  ds_read_b128 v[72:75], v15 offset:57344
  ds_read_b128 v[76:79], v15 offset:41984
  v_mfma_f32_16x16x32_bf16 v[28:31], v[108:111], a[72:75], v[28:31]
  ds_read_b128 v[80:83], v15 offset:46080
  ds_read_b128 v[84:87], v15 offset:50176
  v_mfma_f32_16x16x32_bf16 v[32:35], v[112:115], a[72:75], v[32:35]
  ds_read_b128 v[88:91], v15 offset:54272
  ds_read_b128 v[92:95], v15 offset:58368
  v_mfma_f32_16x16x32_bf16 v[16:19], v[116:119], a[76:79], v[16:19]
  buffer_load_dwordx4 v4, s[8:11], s40 offen offset:0 lds
  buffer_load_dwordx4 v4, s[8:11], s40 offen offset:1024 lds
  v_mfma_f32_16x16x32_bf16 v[20:23], v[120:123], a[76:79], v[20:23]
  buffer_load_dwordx4 v4, s[8:11], s40 offen offset:2048 lds
  buffer_load_dwordx4 v4, s[8:11], s40 offen offset:3072 lds
  v_mfma_f32_16x16x32_bf16 v[24:27], v[124:127], a[76:79], v[24:27]
  s_add_u32 m0, s24, 40960
  s_add_u32 s25, s25, 4096
  buffer_load_dwordx4 v4, s[8:11], s41 offen lds
  s_cmp_eq_u32 s25, 49152
  s_cselect_b32 s25, 0, s25
  v_mfma_f32_16x16x32_bf16 v[28:31], v[128:131], a[76:79], v[28:31]
  s_add_u32 s42, s22, s26
  s_add_u32 s26, s26, 4096
  v_mfma_f32_16x16x32_bf16 v[32:35], v[132:135], a[76:79], v[32:35]
  s_waitcnt lgkmcnt(0)
  v_mfma_f32_16x16x32_bf16 v[16:19], v[56:59], a[80:83], v[16:19]
  ds_read_b128 v[96:99], v15 offset:43008
  ds_read_b128 v[100:103], v15 offset:47104
  v_mfma_f32_16x16x32_bf16 v[20:23], v[60:63], a[80:83], v[20:23]
  ds_read_b128 v[104:107], v15 offset:51200
  ds_read_b128 v[108:111], v15 offset:55296
  v_mfma_f32_16x16x32_bf16 v[24:27], v[64:67], a[80:83], v[24:27]
  ds_read_b128 v[112:115], v15 offset:59392
  ds_read_b128 v[116:119], v15 offset:44032
  v_mfma_f32_16x16x32_bf16 v[28:31], v[68:71], a[80:83], v[28:31]
  ds_read_b128 v[120:123], v15 offset:48128
  ds_read_b128 v[124:127], v15 offset:52224
  v_mfma_f32_16x16x32_bf16 v[32:35], v[72:75], a[80:83], v[32:35]
  ds_read_b128 v[128:131], v15 offset:56320
  ds_read_b128 v[132:135], v15 offset:60416
  v_mfma_f32_16x16x32_bf16 v[16:19], v[76:79], a[84:87], v[16:19]
  buffer_load_dwordx4 a[16:19], v4, s[8:11], s42 offen offset:0
  buffer_load_dwordx4 a[20:23], v4, s[8:11], s42 offen offset:1024
  v_mfma_f32_16x16x32_bf16 v[20:23], v[80:83], a[84:87], v[20:23]
  buffer_load_dwordx4 a[24:27], v4, s[8:11], s42 offen offset:2048
  buffer_load_dwordx4 a[28:31], v4, s[8:11], s42 offen offset:3072
  v_mfma_f32_16x16x32_bf16 v[24:27], v[84:87], a[84:87], v[24:27]
  s_cmp_eq_u32 s26, 49152
  s_cselect_b32 s26, 0, s26
  s_add_u32 s40, s20, s25
  s_add_u32 m0, s23, 61440
  s_add_u32 s41, s21, s25
  v_mfma_f32_16x16x32_bf16 v[28:31], v[88:91], a[84:87], v[28:31]
  buffer_load_dwordx4 v4, s[8:11], s40 offen offset:0 lds
  v_mfma_f32_16x16x32_bf16 v[32:35], v[92:95], a[84:87], v[32:35]
  s_waitcnt lgkmcnt(0)
  s_waitcnt vmcnt(19)
  s_barrier
  v_mfma_f32_16x16x32_bf16 v[16:19], v[96:99], a[88:91], v[16:19]
  ds_read_b128 v[56:59], v14 offset:0
  ds_read_b128 v[60:63], v14 offset:4096
  v_mfma_f32_16x16x32_bf16 v[20:23], v[100:103], a[88:91], v[20:23]
  ds_read_b128 v[64:67], v14 offset:8192
  ds_read_b128 v[68:71], v14 offset:12288
  v_mfma_f32_16x16x32_bf16 v[24:27], v[104:107], a[88:91], v[24:27]
  ds_read_b128 v[72:75], v14 offset:16384
  ds_read_b128 v[76:79], v14 offset:1024
  v_mfma_f32_16x16x32_bf16 v[28:31], v[108:111], a[88:91], v[28:31]
  ds_read_b128 v[80:83], v14 offset:5120
  ds_read_b128 v[84:87], v14 offset:9216
  v_mfma_f32_16x16x32_bf16 v[32:35], v[112:115], a[88:91], v[32:35]
  ds_read_b128 v[88:91], v14 offset:13312
  ds_read_b128 v[92:95], v14 offset:17408
  v_mfma_f32_16x16x32_bf16 v[16:19], v[116:119], a[92:95], v[16:19]
  buffer_load_dwordx4 v4, s[8:11], s40 offen offset:1024 lds
  buffer_load_dwordx4 v4, s[8:11], s40 offen offset:2048 lds
  v_mfma_f32_16x16x32_bf16 v[20:23], v[120:123], a[92:95], v[20:23]
  buffer_load_dwordx4 v4, s[8:11], s40 offen offset:3072 lds
  s_add_u32 m0, s24, 61440
  s_add_u32 s25, s25, 4096
  buffer_load_dwordx4 v4, s[8:11], s41 offen lds
  v_mfma_f32_16x16x32_bf16 v[24:27], v[124:127], a[92:95], v[24:27]
  s_cmp_eq_u32 s25, 49152
  s_cselect_b32 s25, 0, s25
  s_add_u32 s42, s22, s26
  s_add_u32 s26, s26, 4096
  v_mfma_f32_16x16x32_bf16 v[28:31], v[128:131], a[92:95], v[28:31]
  buffer_load_dwordx4 a[32:35], v4, s[8:11], s42 offen offset:0
  v_mfma_f32_16x16x32_bf16 v[32:35], v[132:135], a[92:95], v[32:35]
  s_waitcnt lgkmcnt(0)
  v_mfma_f32_16x16x32_bf16 v[16:19], v[56:59], a[96:99], v[16:19]
  ds_read_b128 v[96:99], v14 offset:2048
  ds_read_b128 v[100:103], v14 offset:6144
  v_mfma_f32_16x16x32_bf16 v[20:23], v[60:63], a[96:99], v[20:23]
  ds_read_b128 v[104:107], v14 offset:10240
  ds_read_b128 v[108:111], v14 offset:14336
  v_mfma_f32_16x16x32_bf16 v[24:27], v[64:67], a[96:99], v[24:27]
  ds_read_b128 v[112:115], v14 offset:18432
  ds_read_b128 v[116:119], v14 offset:3072
  v_mfma_f32_16x16x32_bf16 v[28:31], v[68:71], a[96:99], v[28:31]
  ds_read_b128 v[120:123], v14 offset:7168
  ds_read_b128 v[124:127], v14 offset:11264
  v_mfma_f32_16x16x32_bf16 v[32:35], v[72:75], a[96:99], v[32:35]
  ds_read_b128 v[128:131], v14 offset:15360
  ds_read_b128 v[132:135], v14 offset:19456
  v_mfma_f32_16x16x32_bf16 v[16:19], v[76:79], a[100:103], v[16:19]
  buffer_load_dwordx4 a[36:39], v4, s[8:11], s42 offen offset:1024
  buffer_load_dwordx4 a[40:43], v4, s[8:11], s42 offen offset:2048
  v_mfma_f32_16x16x32_bf16 v[20:23], v[80:83], a[100:103], v[20:23]
  buffer_load_dwordx4 a[44:47], v4, s[8:11], s42 offen offset:3072
  s_cmp_eq_u32 s26, 49152
  s_cselect_b32 s26, 0, s26
  v_mfma_f32_16x16x32_bf16 v[24:27], v[84:87], a[100:103], v[24:27]
  s_add_u32 s40, s20, s25
  s_add_u32 m0, s23, 81920
  s_add_u32 s41, s21, s25
  buffer_load_dwordx4 v4, s[8:11], s40 offen offset:0 lds
  v_mfma_f32_16x16x32_bf16 v[28:31], v[88:91], a[100:103], v[28:31]
  buffer_load_dwordx4 v4, s[8:11], s40 offen offset:1024 lds
  v_mfma_f32_16x16x32_bf16 v[32:35], v[92:95], a[100:103], v[32:35]
  s_waitcnt lgkmcnt(0)
  s_waitcnt vmcnt(20)
  s_barrier
  v_mfma_f32_16x16x32_bf16 v[16:19], v[96:99], a[104:107], v[16:19]
  ds_read_b128 v[56:59], v14 offset:20480
  ds_read_b128 v[60:63], v14 offset:24576
  v_mfma_f32_16x16x32_bf16 v[20:23], v[100:103], a[104:107], v[20:23]
  ds_read_b128 v[64:67], v14 offset:28672
  ds_read_b128 v[68:71], v14 offset:32768
  v_mfma_f32_16x16x32_bf16 v[24:27], v[104:107], a[104:107], v[24:27]
  ds_read_b128 v[72:75], v14 offset:36864
  ds_read_b128 v[76:79], v14 offset:21504
  v_mfma_f32_16x16x32_bf16 v[28:31], v[108:111], a[104:107], v[28:31]
  ds_read_b128 v[80:83], v14 offset:25600
  ds_read_b128 v[84:87], v14 offset:29696
  v_mfma_f32_16x16x32_bf16 v[32:35], v[112:115], a[104:107], v[32:35]
  ds_read_b128 v[88:91], v14 offset:33792
  ds_read_b128 v[92:95], v14 offset:37888
  v_mfma_f32_16x16x32_bf16 v[16:19], v[116:119], a[108:111], v[16:19]
  buffer_load_dwordx4 v4, s[8:11], s40 offen offset:2048 lds
  buffer_load_dwordx4 v4, s[8:11], s40 offen offset:3072 lds
  v_mfma_f32_16x16x32_bf16 v[20:23], v[120:123], a[108:111], v[20:23]
  s_add_u32 m0, s24, 81920
  s_add_u32 s25, s25, 4096
  buffer_load_dwordx4 v4, s[8:11], s41 offen lds
  s_cmp_eq_u32 s25, 49152
  s_cselect_b32 s25, 0, s25
  v_mfma_f32_16x16x32_bf16 v[24:27], v[124:127], a[108:111], v[24:27]
  s_add_u32 s42, s22, s26
  s_add_u32 s26, s26, 4096
  buffer_load_dwordx4 a[48:51], v4, s[8:11], s42 offen offset:0
  v_mfma_f32_16x16x32_bf16 v[28:31], v[128:131], a[108:111], v[28:31]
  buffer_load_dwordx4 a[52:55], v4, s[8:11], s42 offen offset:1024
  v_mfma_f32_16x16x32_bf16 v[32:35], v[132:135], a[108:111], v[32:35]
  s_waitcnt lgkmcnt(0)
  v_mfma_f32_16x16x32_bf16 v[16:19], v[56:59], a[0:3], v[16:19]
  ds_read_b128 v[96:99], v14 offset:22528
  ds_read_b128 v[100:103], v14 offset:26624
  v_mfma_f32_16x16x32_bf16 v[20:23], v[60:63], a[0:3], v[20:23]
  ds_read_b128 v[104:107], v14 offset:30720
  ds_read_b128 v[108:111], v14 offset:34816
  v_mfma_f32_16x16x32_bf16 v[24:27], v[64:67], a[0:3], v[24:27]
  ds_read_b128 v[112:115], v14 offset:38912
  ds_read_b128 v[116:119], v14 offset:23552
  v_mfma_f32_16x16x32_bf16 v[28:31], v[68:71], a[0:3], v[28:31]
  ds_read_b128 v[120:123], v14 offset:27648
  ds_read_b128 v[124:127], v14 offset:31744
  v_mfma_f32_16x16x32_bf16 v[32:35], v[72:75], a[0:3], v[32:35]
  ds_read_b128 v[128:131], v14 offset:35840
  ds_read_b128 v[132:135], v14 offset:39936
  v_mfma_f32_16x16x32_bf16 v[16:19], v[76:79], a[4:7], v[16:19]
  buffer_load_dwordx4 a[56:59], v4, s[8:11], s42 offen offset:2048
  buffer_load_dwordx4 a[60:63], v4, s[8:11], s42 offen offset:3072
  v_mfma_f32_16x16x32_bf16 v[20:23], v[80:83], a[4:7], v[20:23]
  s_cmp_eq_u32 s26, 49152
  s_cselect_b32 s26, 0, s26
  s_add_u32 s40, s20, s25
  s_add_u32 m0, s23, 102400
  s_add_u32 s41, s21, s25
  v_mfma_f32_16x16x32_bf16 v[24:27], v[84:87], a[4:7], v[24:27]
  buffer_load_dwordx4 v4, s[8:11], s40 offen offset:0 lds
  buffer_load_dwordx4 v4, s[8:11], s40 offen offset:1024 lds
  v_mfma_f32_16x16x32_bf16 v[28:31], v[88:91], a[4:7], v[28:31]
  buffer_load_dwordx4 v4, s[8:11], s40 offen offset:2048 lds
  v_mfma_f32_16x16x32_bf16 v[32:35], v[92:95], a[4:7], v[32:35]
  s_waitcnt lgkmcnt(0)
  s_waitcnt vmcnt(21)
  s_barrier
  v_mfma_f32_16x16x32_bf16 v[16:19], v[96:99], a[8:11], v[16:19]
  ds_read_b128 v[56:59], v14 offset:40960
  ds_read_b128 v[60:63], v14 offset:45056
  v_mfma_f32_16x16x32_bf16 v[20:23], v[100:103], a[8:11], v[20:23]
  ds_read_b128 v[64:67], v14 offset:49152
  ds_read_b128 v[68:71], v14 offset:53248
  v_mfma_f32_16x16x32_bf16 v[24:27], v[104:107], a[8:11], v[24:27]
  ds_read_b128 v[72:75], v14 offset:57344
  ds_read_b128 v[76:79], v14 offset:41984
  v_mfma_f32_16x16x32_bf16 v[28:31], v[108:111], a[8:11], v[28:31]
  ds_read_b128 v[80:83], v14 offset:46080
  ds_read_b128 v[84:87], v14 offset:50176
  v_mfma_f32_16x16x32_bf16 v[32:35], v[112:115], a[8:11], v[32:35]
  ds_read_b128 v[88:91], v14 offset:54272
  ds_read_b128 v[92:95], v14 offset:58368
  v_mfma_f32_16x16x32_bf16 v[16:19], v[116:119], a[12:15], v[16:19]
  buffer_load_dwordx4 v4, s[8:11], s40 offen offset:3072 lds
  s_add_u32 m0, s24, 102400
  s_add_u32 s25, s25, 4096
  buffer_load_dwordx4 v4, s[8:11], s41 offen lds
  v_mfma_f32_16x16x32_bf16 v[20:23], v[120:123], a[12:15], v[20:23]
  s_cmp_eq_u32 s25, 49152
  s_cselect_b32 s25, 0, s25
  s_add_u32 s42, s22, s26
  s_add_u32 s26, s26, 4096
  v_mfma_f32_16x16x32_bf16 v[24:27], v[124:127], a[12:15], v[24:27]
  buffer_load_dwordx4 a[64:67], v4, s[8:11], s42 offen offset:0
  buffer_load_dwordx4 a[68:71], v4, s[8:11], s42 offen offset:1024
  v_mfma_f32_16x16x32_bf16 v[28:31], v[128:131], a[12:15], v[28:31]
  buffer_load_dwordx4 a[72:75], v4, s[8:11], s42 offen offset:2048
  v_mfma_f32_16x16x32_bf16 v[32:35], v[132:135], a[12:15], v[32:35]
  s_waitcnt lgkmcnt(0)
  v_mfma_f32_16x16x32_bf16 v[16:19], v[56:59], a[16:19], v[16:19]
  ds_read_b128 v[96:99], v14 offset:43008
  ds_read_b128 v[100:103], v14 offset:47104
  v_mfma_f32_16x16x32_bf16 v[20:23], v[60:63], a[16:19], v[20:23]
  ds_read_b128 v[104:107], v14 offset:51200
  ds_read_b128 v[108:111], v14 offset:55296
  v_mfma_f32_16x16x32_bf16 v[24:27], v[64:67], a[16:19], v[24:27]
  ds_read_b128 v[112:115], v14 offset:59392
  ds_read_b128 v[116:119], v14 offset:44032
  v_mfma_f32_16x16x32_bf16 v[28:31], v[68:71], a[16:19], v[28:31]
  ds_read_b128 v[120:123], v14 offset:48128
  ds_read_b128 v[124:127], v14 offset:52224
  v_mfma_f32_16x16x32_bf16 v[32:35], v[72:75], a[16:19], v[32:35]
  ds_read_b128 v[128:131], v14 offset:56320
  ds_read_b128 v[132:135], v14 offset:60416
  v_mfma_f32_16x16x32_bf16 v[16:19], v[76:79], a[20:23], v[16:19]
  buffer_load_dwordx4 a[76:79], v4, s[8:11], s42 offen offset:3072
  s_cmp_eq_u32 s26, 49152
  s_cselect_b32 s26, 0, s26
  v_mfma_f32_16x16x32_bf16 v[20:23], v[80:83], a[20:23], v[20:23]
  v_mfma_f32_16x16x32_bf16 v[24:27], v[84:87], a[20:23], v[24:27]
  v_mfma_f32_16x16x32_bf16 v[28:31], v[88:91], a[20:23], v[28:31]
  v_mfma_f32_16x16x32_bf16 v[32:35], v[92:95], a[20:23], v[32:35]
  s_waitcnt lgkmcnt(0)
  s_waitcnt vmcnt(18)
  s_barrier
  v_mfma_f32_16x16x32_bf16 v[16:19], v[96:99], a[24:27], v[16:19]
  ds_read_b128 v[56:59], v15 offset:0
  ds_read_b128 v[60:63], v15 offset:4096
  v_mfma_f32_16x16x32_bf16 v[20:23], v[100:103], a[24:27], v[20:23]
  ds_read_b128 v[64:67], v15 offset:8192
  ds_read_b128 v[68:71], v15 offset:12288
  v_mfma_f32_16x16x32_bf16 v[24:27], v[104:107], a[24:27], v[24:27]
  ds_read_b128 v[72:75], v15 offset:16384
  ds_read_b128 v[76:79], v15 offset:1024
  v_mfma_f32_16x16x32_bf16 v[28:31], v[108:111], a[24:27], v[28:31]
  ds_read_b128 v[80:83], v15 offset:5120
  ds_read_b128 v[84:87], v15 offset:9216
  v_mfma_f32_16x16x32_bf16 v[32:35], v[112:115], a[24:27], v[32:35]
  ds_read_b128 v[88:91], v15 offset:13312
  ds_read_b128 v[92:95], v15 offset:17408
  v_mfma_f32_16x16x32_bf16 v[16:19], v[116:119], a[28:31], v[16:19]
  v_mfma_f32_16x16x32_bf16 v[20:23], v[120:123], a[28:31], v[20:23]
  v_mfma_f32_16x16x32_bf16 v[24:27], v[124:127], a[28:31], v[24:27]
  v_mfma_f32_16x16x32_bf16 v[28:31], v[128:131], a[28:31], v[28:31]
  v_mfma_f32_16x16x32_bf16 v[32:35], v[132:135], a[28:31], v[32:35]
  s_waitcnt lgkmcnt(0)
  v_mfma_f32_16x16x32_bf16 v[16:19], v[56:59], a[32:35], v[16:19]
  ds_read_b128 v[96:99], v15 offset:2048
  ds_read_b128 v[100:103], v15 offset:6144
  v_mfma_f32_16x16x32_bf16 v[20:23], v[60:63], a[32:35], v[20:23]
  ds_read_b128 v[104:107], v15 offset:10240
  ds_read_b128 v[108:111], v15 offset:14336
  v_mfma_f32_16x16x32_bf16 v[24:27], v[64:67], a[32:35], v[24:27]
  ds_read_b128 v[112:115], v15 offset:18432
  ds_read_b128 v[116:119], v15 offset:3072
  v_mfma_f32_16x16x32_bf16 v[28:31], v[68:71], a[32:35], v[28:31]
  ds_read_b128 v[120:123], v15 offset:7168
  ds_read_b128 v[124:127], v15 offset:11264
  v_mfma_f32_16x16x32_bf16 v[32:35], v[72:75], a[32:35], v[32:35]
  ds_read_b128 v[128:131], v15 offset:15360
  ds_read_b128 v[132:135], v15 offset:19456
  v_mfma_f32_16x16x32_bf16 v[16:19], v[76:79], a[36:39], v[16:19]
  v_mfma_f32_16x16x32_bf16 v[20:23], v[80:83], a[36:39], v[20:23]
  v_mfma_f32_16x16x32_bf16 v[24:27], v[84:87], a[36:39], v[24:27]
  v_mfma_f32_16x16x32_bf16 v[28:31], v[88:91], a[36:39], v[28:31]
  v_mfma_f32_16x16x32_bf16 v[32:35], v[92:95], a[36:39], v[32:35]
  s_waitcnt lgkmcnt(0)
  s_waitcnt vmcnt(9)
  s_barrier
  v_mfma_f32_16x16x32_bf16 v[16:19], v[96:99], a[40:43], v[16:19]
  ds_read_b128 v[56:59], v15 offset:20480
  ds_read_b128 v[60:63], v15 offset:24576
  v_mfma_f32_16x16x32_bf16 v[20:23], v[100:103], a[40:43], v[20:23]
  ds_read_b128 v[64:67], v15 offset:28672
  ds_read_b128 v[68:71], v15 offset:32768
  v_mfma_f32_16x16x32_bf16 v[24:27], v[104:107], a[40:43], v[24:27]
  ds_read_b128 v[72:75], v15 offset:36864
  ds_read_b128 v[76:79], v15 offset:21504
  v_mfma_f32_16x16x32_bf16 v[28:31], v[108:111], a[40:43], v[28:31]
  ds_read_b128 v[80:83], v15 offset:25600
  ds_read_b128 v[84:87], v15 offset:29696
  v_mfma_f32_16x16x32_bf16 v[32:35], v[112:115], a[40:43], v[32:35]
  ds_read_b128 v[88:91], v15 offset:33792
  ds_read_b128 v[92:95], v15 offset:37888
  v_mfma_f32_16x16x32_bf16 v[16:19], v[116:119], a[44:47], v[16:19]
  s_lshl_b32 s43, s7, 10
  s_lshl_b32 s44, s6, 5
  s_add_u32 s43, s43, s44
  s_add_u32 s43, s43, s4
  s_mul_i32 s43, s43, 1280
  s_mul_i32 s44, s5, 160
  s_add_u32 s43, s43, s44
  v_add_u32 v184, 0, v1
  v_mul_u32_u24 v185, 205, v184
  v_lshrrev_b32 v185, 11, v185
  v_mul_u32_u24 v186, 10, v185
  v_sub_u32 v186, v184, v186
  v_mfma_f32_16x16x32_bf16 v[20:23], v[120:123], a[44:47], v[20:23]
  v_mul_u32_u24 v187, 0x14000, v185
  v_lshl_add_u32 v176, v186, 4, v187
  v_mul_u32_u24 v187, 336, v185
  v_lshl_add_u32 v180, v186, 5, v187
  v_add_u32 v184, 64, v1
  v_mul_u32_u24 v185, 205, v184
  v_lshrrev_b32 v185, 11, v185
  v_mul_u32_u24 v186, 10, v185
  v_sub_u32 v186, v184, v186
  v_mfma_f32_16x16x32_bf16 v[24:27], v[124:127], a[44:47], v[24:27]
  v_mul_u32_u24 v187, 0x14000, v185
  v_lshl_add_u32 v177, v186, 4, v187
  v_mul_u32_u24 v187, 336, v185
  v_lshl_add_u32 v181, v186, 5, v187
  v_add_u32 v184, 128, v1
  v_mul_u32_u24 v185, 205, v184
  v_lshrrev_b32 v185, 11, v185
  v_mul_u32_u24 v186, 10, v185
  v_sub_u32 v186, v184, v186
  v_mfma_f32_16x16x32_bf16 v[28:31], v[128:131], a[44:47], v[28:31]
  v_mul_u32_u24 v187, 0x14000, v185
  v_lshl_add_u32 v178, v186, 4, v187
  v_mul_u32_u24 v187, 336, v185
  v_lshl_add_u32 v182, v186, 5, v187
  buffer_load_dwordx4 v[152:155], v176, s[12:15], s43 offen
  v_mfma_f32_16x16x32_bf16 v[32:35], v[132:135], a[44:47], v[32:35]
  buffer_load_dwordx4 v[156:159], v177, s[12:15], s43 offen
  s_mov_b32 exec_hi, 0
  buffer_load_dwordx4 v[160:163], v178, s[12:15], s43 offen
  s_mov_b32 exec_hi, -1
  s_waitcnt lgkmcnt(0)
  v_mfma_f32_16x16x32_bf16 v[16:19], v[56:59], a[48:51], v[16:19]
  ds_read_b128 v[96:99], v15 offset:22528
  ds_read_b128 v[100:103], v15 offset:26624
  v_mfma_f32_16x16x32_bf16 v[20:23], v[60:63], a[48:51], v[20:23]
  ds_read_b128 v[104:107], v15 offset:30720
  ds_read_b128 v[108:111], v15 offset:34816
  v_mfma_f32_16x16x32_bf16 v[24:27], v[64:67], a[48:51], v[24:27]
  ds_read_b128 v[112:115], v15 offset:38912
  ds_read_b128 v[116:119], v15 offset:23552
  v_mfma_f32_16x16x32_bf16 v[28:31], v[68:71], a[48:51], v[28:31]
  ds_read_b128 v[120:123], v15 offset:27648
  ds_read_b128 v[124:127], v15 offset:31744
  v_mfma_f32_16x16x32_bf16 v[32:35], v[72:75], a[48:51], v[32:35]
  ds_read_b128 v[128:131], v15 offset:35840
  ds_read_b128 v[132:135], v15 offset:39936
  v_mfma_f32_16x16x32_bf16 v[16:19], v[76:79], a[52:55], v[16:19]
  v_mfma_f32_16x16x32_bf16 v[20:23], v[80:83], a[52:55], v[20:23]
  v_mfma_f32_16x16x32_bf16 v[24:27], v[84:87], a[52:55], v[24:27]
  v_mfma_f32_16x16x32_bf16 v[28:31], v[88:91], a[52:55], v[28:31]
  v_mfma_f32_16x16x32_bf16 v[32:35], v[92:95], a[52:55], v[32:35]
  s_waitcnt lgkmcnt(0)
  s_waitcnt vmcnt(3)
  s_barrier
  v_mfma_f32_16x16x32_bf16 v[16:19], v[96:99], a[56:59], v[16:19]
  ds_read_b128 v[56:59], v15 offset:40960
  ds_read_b128 v[60:63], v15 offset:45056
  v_mfma_f32_16x16x32_bf16 v[20:23], v[100:103], a[56:59], v[20:23]
  ds_read_b128 v[64:67], v15 offset:49152
  ds_read_b128 v[68:71], v15 offset:53248
  v_mfma_f32_16x16x32_bf16 v[24:27], v[104:107], a[56:59], v[24:27]
  ds_read_b128 v[72:75], v15 offset:57344
  ds_read_b128 v[76:79], v15 offset:41984
  v_mfma_f32_16x16x32_bf16 v[28:31], v[108:111], a[56:59], v[28:31]
  ds_read_b128 v[80:83], v15 offset:46080
  ds_read_b128 v[84:87], v15 offset:50176
  v_mfma_f32_16x16x32_bf16 v[32:35], v[112:115], a[56:59], v[32:35]
  ds_read_b128 v[88:91], v15 offset:54272
  ds_read_b128 v[92:95], v15 offset:58368
  v_mfma_f32_16x16x32_bf16 v[16:19], v[116:119], a[60:63], v[16:19]
  v_mfma_f32_16x16x32_bf16 v[20:23], v[120:123], a[60:63], v[20:23]
  v_mfma_f32_16x16x32_bf16 v[24:27], v[124:127], a[60:63], v[24:27]
  v_mfma_f32_16x16x32_bf16 v[28:31], v[128:131], a[60:63], v[28:31]
  v_mfma_f32_16x16x32_bf16 v[32:35], v[132:135], a[60:63], v[32:35]
  s_waitcnt lgkmcnt(0)
  v_mfma_f32_16x16x32_bf16 v[16:19], v[56:59], a[64:67], v[16:19]
  ds_read_b128 v[96:99], v15 offset:43008
  ds_read_b128 v[100:103], v15 offset:47104
  v_mfma_f32_16x16x32_bf16 v[20:23], v[60:63], a[64:67], v[20:23]
  ds_read_b128 v[104:107], v15 offset:51200
  ds_read_b128 v[108:111], v15 offset:55296
  v_mfma_f32_16x16x32_bf16 v[24:27], v[64:67], a[64:67], v[24:27]
  ds_read_b128 v[112:115], v15 offset:59392
  ds_read_b128 v[116:119], v15 offset:44032
  v_mfma_f32_16x16x32_bf16 v[28:31], v[68:71], a[64:67], v[28:31]
  ds_read_b128 v[120:123], v15 offset:48128
  ds_read_b128 v[124:127], v15 offset:52224
  v_mfma_f32_16x16x32_bf16 v[32:35], v[72:75], a[64:67], v[32:35]
  ds_read_b128 v[128:131], v15 offset:56320
  ds_read_b128 v[132:135], v15 offset:60416
  v_mfma_f32_16x16x32_bf16 v[16:19], v[76:79], a[68:71], v[16:19]
  v_mfma_f32_16x16x32_bf16 v[20:23], v[80:83], a[68:71], v[20:23]
  v_mfma_f32_16x16x32_bf16 v[24:27], v[84:87], a[68:71], v[24:27]
  v_mfma_f32_16x16x32_bf16 v[28:31], v[88:91], a[68:71], v[28:31]
  v_mfma_f32_16x16x32_bf16 v[32:35], v[92:95], a[68:71], v[32:35]
  s_waitcnt lgkmcnt(0)
  v_mfma_f32_16x16x32_bf16 v[16:19], v[96:99], a[72:75], v[16:19]
  v_mfma_f32_16x16x32_bf16 v[20:23], v[100:103], a[72:75], v[20:23]
  v_mfma_f32_16x16x32_bf16 v[24:27], v[104:107], a[72:75], v[24:27]
  v_mfma_f32_16x16x32_bf16 v[28:31], v[108:111], a[72:75], v[28:31]
  v_mfma_f32_16x16x32_bf16 v[32:35], v[112:115], a[72:75], v[32:35]
  v_mfma_f32_16x16x32_bf16 v[16:19], v[116:119], a[76:79], v[16:19]
  v_mfma_f32_16x16x32_bf16 v[20:23], v[120:123], a[76:79], v[20:23]
  v_mfma_f32_16x16x32_bf16 v[24:27], v[124:127], a[76:79], v[24:27]
  v_mfma_f32_16x16x32_bf16 v[28:31], v[128:131], a[76:79], v[28:31]
  v_mfma_f32_16x16x32_bf16 v[32:35], v[132:135], a[76:79], v[32:35]
  s_cmp_eq_u32 s5, 0
  s_cselect_b32 s44, 0xffff, 0
  s_mov_b32 s45, 0
  s_mov_b32 s40, 0xbfb8aa3b
  v_mov_b32 v188, s40
  v_mov_b32 v189, s40
  v_mov_b32 v190, 1.0
  v_mov_b32 v191, 1.0
  v_cndmask_b32_e64 v36, v36, 0, s[44:45]
  s_mul_i32 s46, s3, 20480
  v_mul_u32_u24 v5, 336, v2
  v_lshl_add_u32 v5, v3, 4, v5
  v_add_u32 v5, s46, v5
  v_add_u32 v180, s46, v180
  v_add_u32 v181, s46, v181
  v_add_u32 v182, s46, v182
  s_nop 1
  v_pk_mul_f32 v[56:57], v[16:17], v[188:189]
  v_pk_mul_f32 v[58:59], v[18:19], v[188:189]
  v_pk_mul_f32 v[60:61], v[20:21], v[188:189]
  v_pk_mul_f32 v[62:63], v[22:23], v[188:189]
  v_pk_mul_f32 v[64:65], v[24:25], v[188:189]
  v_pk_mul_f32 v[66:67], v[26:27], v[188:189]
  v_pk_mul_f32 v[68:69], v[28:29], v[188:189]
  v_pk_mul_f32 v[70:71], v[30:31], v[188:189]
  v_pk_mul_f32 v[72:73], v[32:33], v[188:189]
  v_pk_mul_f32 v[74:75], v[34:35], v[188:189]
  v_exp_f32 v56, v56
  v_exp_f32 v57, v57
  v_exp_f32 v58, v58
  v_exp_f32 v59, v59
  v_exp_f32 v60, v60
  v_exp_f32 v61, v61
  v_exp_f32 v62, v62
  v_exp_f32 v63, v63
  v_exp_f32 v64, v64
  v_exp_f32 v65, v65
  v_exp_f32 v66, v66
  v_exp_f32 v67, v67
  v_exp_f32 v68, v68
  v_exp_f32 v69, v69
  v_exp_f32 v70, v70
  v_exp_f32 v71, v71
  v_exp_f32 v72, v72
  v_exp_f32 v73, v73
  v_exp_f32 v74, v74
  v_exp_f32 v75, v75
  v_pk_mul_f32 v[36:37], v[36:37], v[16:17]
  v_pk_mul_f32 v[38:39], v[38:39], v[18:19]
  v_pk_mul_f32 v[40:41], v[40:41], v[20:21]
  v_pk_mul_f32 v[42:43], v[42:43], v[22:23]
  v_pk_mul_f32 v[44:45], v[44:45], v[24:25]
  v_pk_mul_f32 v[46:47], v[46:47], v[26:27]
  v_pk_mul_f32 v[48:49], v[48:49], v[28:29]
  v_pk_mul_f32 v[50:51], v[50:51], v[30:31]
  v_pk_mul_f32 v[52:53], v[52:53], v[32:33]
  v_pk_mul_f32 v[54:55], v[54:55], v[34:35]
  v_pk_add_f32 v[56:57], v[56:57], v[190:191]
  v_pk_add_f32 v[58:59], v[58:59], v[190:191]
  v_pk_add_f32 v[60:61], v[60:61], v[190:191]
  v_pk_add_f32 v[62:63], v[62:63], v[190:191]
  v_pk_add_f32 v[64:65], v[64:65], v[190:191]
  v_pk_add_f32 v[66:67], v[66:67], v[190:191]
  v_pk_add_f32 v[68:69], v[68:69], v[190:191]
  v_pk_add_f32 v[70:71], v[70:71], v[190:191]
  v_pk_add_f32 v[72:73], v[72:73], v[190:191]
  v_pk_add_f32 v[74:75], v[74:75], v[190:191]
  v_rcp_f32 v56, v56
  v_rcp_f32 v57, v57
  v_rcp_f32 v58, v58
  v_rcp_f32 v59, v59
  v_rcp_f32 v60, v60
  v_rcp_f32 v61, v61
  v_rcp_f32 v62, v62
  v_rcp_f32 v63, v63
  v_rcp_f32 v64, v64
  v_rcp_f32 v65, v65
  v_rcp_f32 v66, v66
  v_rcp_f32 v67, v67
  v_rcp_f32 v68, v68
  v_rcp_f32 v69, v69
  v_rcp_f32 v70, v70
  v_rcp_f32 v71, v71
  v_rcp_f32 v72, v72
  v_rcp_f32 v73, v73
  v_rcp_f32 v74, v74
  v_rcp_f32 v75, v75
  s_nop 0
  v_pk_mul_f32 v[36:37], v[36:37], v[56:57]
  v_pk_mul_f32 v[38:39], v[38:39], v[58:59]
  ds_write_b128 v5, v[36:39] offset:0
  v_pk_mul_f32 v[40:41], v[40:41], v[60:61]
  v_pk_mul_f32 v[42:43], v[42:43], v[62:63]
  ds_write_b128 v5, v[40:43] offset:64
  v_pk_mul_f32 v[44:45], v[44:45], v[64:65]
  v_pk_mul_f32 v[46:47], v[46:47], v[66:67]
  ds_write_b128 v5, v[44:47] offset:128
  v_pk_mul_f32 v[48:49], v[48:49], v[68:69]
  v_pk_mul_f32 v[50:51], v[50:51], v[70:71]
  ds_write_b128 v5, v[48:51] offset:192
  v_pk_mul_f32 v[52:53], v[52:53], v[72:73]
  v_pk_mul_f32 v[54:55], v[54:55], v[74:75]
  ds_write_b128 v5, v[52:55] offset:256
  s_waitcnt lgkmcnt(0)
  ds_read_b128 v[96:99], v180
  ds_read_b128 v[100:103], v180 offset:16
  ds_read_b128 v[104:107], v181
  ds_read_b128 v[108:111], v181 offset:16
  ds_read_b128 v[112:115], v182
  ds_read_b128 v[116:119], v182 offset:16
  s_waitcnt vmcnt(0)
  v_lshlrev_b32 v192, 16, v152
  v_and_b32 v193, 0xffff0000, v152
  v_lshlrev_b32 v194, 16, v153
  v_and_b32 v195, 0xffff0000, v153
  v_lshlrev_b32 v196, 16, v154
  v_and_b32 v197, 0xffff0000, v154
  v_lshlrev_b32 v198, 16, v155
  v_and_b32 v199, 0xffff0000, v155
  v_lshlrev_b32 v200, 16, v156
  v_and_b32 v201, 0xffff0000, v156
  v_lshlrev_b32 v202, 16, v157
  v_and_b32 v203, 0xffff0000, v157
  v_lshlrev_b32 v204, 16, v158
  v_and_b32 v205, 0xffff0000, v158
  v_lshlrev_b32 v206, 16, v159
  v_and_b32 v207, 0xffff0000, v159
  v_lshlrev_b32 v208, 16, v160
  v_and_b32 v209, 0xffff0000, v160
  v_lshlrev_b32 v210, 16, v161
  v_and_b32 v211, 0xffff0000, v161
  v_lshlrev_b32 v212, 16, v162
  v_and_b32 v213, 0xffff0000, v162
  v_lshlrev_b32 v214, 16, v163
  v_and_b32 v215, 0xffff0000, v163
  s_waitcnt lgkmcnt(0)
  v_pk_add_f32 v[192:193], v[192:193], v[96:97]
  v_pk_add_f32 v[194:195], v[194:195], v[98:99]
  v_pk_add_f32 v[196:197], v[196:197], v[100:101]
  v_pk_add_f32 v[198:199], v[198:199], v[102:103]
  v_cvt_pk_bf16_f32 v152, v192, v193
  v_cvt_pk_bf16_f32 v153, v194, v195
  v_cvt_pk_bf16_f32 v154, v196, v197
  v_cvt_pk_bf16_f32 v155, v198, v199
  buffer_store_dwordx4 v[152:155], v176, s[16:19], s43 offen
  v_pk_add_f32 v[200:201], v[200:201], v[104:105]
  v_pk_add_f32 v[202:203], v[202:203], v[106:107]
  v_pk_add_f32 v[204:205], v[204:205], v[108:109]
  v_pk_add_f32 v[206:207], v[206:207], v[110:111]
  v_cvt_pk_bf16_f32 v156, v200, v201
  v_cvt_pk_bf16_f32 v157, v202, v203
  v_cvt_pk_bf16_f32 v158, v204, v205
  v_cvt_pk_bf16_f32 v159, v206, v207
  buffer_store_dwordx4 v[156:159], v177, s[16:19], s43 offen
  v_pk_add_f32 v[208:209], v[208:209], v[112:113]
  v_pk_add_f32 v[210:211], v[210:211], v[114:115]
  v_pk_add_f32 v[212:213], v[212:213], v[116:117]
  v_pk_add_f32 v[214:215], v[214:215], v[118:119]
  v_cvt_pk_bf16_f32 v160, v208, v209
  v_cvt_pk_bf16_f32 v161, v210, v211
  v_cvt_pk_bf16_f32 v162, v212, v213
  v_cvt_pk_bf16_f32 v163, v214, v215
  s_mov_b32 exec_hi, 0
  buffer_store_dwordx4 v[160:163], v178, s[16:19], s43 offen
L2_END:
  s_endpgm
.section .rodata,"a"
.p2align 6
.amdhsa_kernel recurrent_scan__spectral_fnet__dense_activation_silu__prompt_kernel
  .amdhsa_next_free_vgpr 168
  .amdhsa_next_free_sgpr 102
  .amdhsa_accum_offset 168
  .amdhsa_group_segment_fixed_size 0
  .amdhsa_kernarg_size 88
  .amdhsa_user_sgpr_count 2
  .amdhsa_user_sgpr_kernarg_segment_ptr 1
  .amdhsa_system_sgpr_workgroup_id_x 1
.end_amdhsa_kernel
.p2align 6
.amdhsa_kernel fnet_l2_kernel
  .amdhsa_next_free_vgpr 512
  .amdhsa_next_free_sgpr 102
  .amdhsa_accum_offset 256
  .amdhsa_group_segment_fixed_size 0
  .amdhsa_kernarg_size 88
  .amdhsa_user_sgpr_count 2
  .amdhsa_user_sgpr_kernarg_segment_ptr 1
  .amdhsa_system_sgpr_workgroup_id_x 1
.end_amdhsa_kernel
```
